```python
import torch

def _softmax(x, axis=-1):
    return torch.softmax(x, dim=axis)

def _gelu(x):
    return torch.nn.functional.gelu(x, approximate='tanh')

def _silu(x):
    return torch.nn.functional.silu(x)

def _sigmoid(x):
    return torch.sigmoid(x)

def _layernorm(x, axis=-1, eps=1e-05):
    m = x.mean(dim=axis, keepdim=True)
    v = x.var(dim=axis, keepdim=True, unbiased=False)
    return (x - m) / torch.sqrt(v + eps)

def _scatter_add(tgt, idx, src, axis=0):
    return tgt.clone().index_add_(axis, idx, src)

def _segment_sum(src, seg, n):
    out = torch.zeros((n,) + src.shape[1:], dtype=src.dtype)
    return out.index_add_(0, seg, src)

def _pad(x, pw):
    flat = tuple((v for pair in reversed(pw) for v in pair))
    return torch.nn.functional.pad(x, flat)
kernel_name = 'adaLN_cond__ssm_conv_h3__geglu_ffn__prompt'

def setup_inputs():

    _w = lambda a: (lambda t: t.to(torch.bfloat16) if t.is_floating_point() else t)(torch.as_tensor(a))

    def _A_setup():
        B, S, D = (1, 2048, 448)
        ks = 4
        return {'q': _w((lambda *s: torch.randn(*s, dtype=torch.bfloat16) * 0.05)(B, S, D)), 'k': _w((lambda *s: torch.randn(*s, dtype=torch.bfloat16) * 0.8)(B, S, D)), 'v': _w((lambda *s: torch.randn(*s, dtype=torch.bfloat16) * 0.8)(B, S, D)), 'shift_k': _w((lambda *s: torch.randn(*s, dtype=torch.bfloat16) * 0.8)(D, ks) * 0.5), 'ssm_k': _w((lambda *s: torch.randn(*s, dtype=torch.bfloat16) * 0.8)(D, S) * (1.0 / S ** 0.5)), 'ssm_D': _w((lambda *s: torch.randn(*s, dtype=torch.bfloat16) * 0.8)(D))}
    _A_in = _A_setup()

    def _B_setup():
        B, S, D, F = (1, 2048, 448, 1792)
        return {'x': _w((lambda *s: torch.randn(*s, dtype=torch.bfloat16) * 0.05)(B, S, D)), 'w_gate': _w((lambda *s: torch.randn(*s, dtype=torch.bfloat16) * 0.05)(D, F)), 'w_up': _w((lambda *s: torch.randn(*s, dtype=torch.bfloat16) * 0.05)(D, F)), 'w_down': _w((lambda *s: torch.randn(*s, dtype=torch.bfloat16) * 0.05)(F, D))}
    _B_in = _B_setup()
    return {'A_q': _A_in['q'], 'A_k': _A_in['k'], 'A_v': _A_in['v'], 'A_shift_k': _A_in['shift_k'], 'A_ssm_k': _A_in['ssm_k'], 'A_ssm_D': _A_in['ssm_D'], 'B_x': _B_in['x'], 'B_w_gate': _B_in['w_gate'], 'B_w_up': _B_in['w_up'], 'B_w_down': _B_in['w_down'], 'c': _w((lambda *s: torch.randn(*s, dtype=torch.bfloat16) * 0.1)(1, 448) * 8.0), 'w_mod': _w((lambda *s: torch.randn(*s, dtype=torch.bfloat16) * 0.1)(448, 6 * 448) * 448 ** (-0.5) * 8.0)}

def reference(A_q, A_k, A_v, A_shift_k, A_ssm_k, A_ssm_D, B_x, B_w_gate, B_w_up, B_w_down, c, w_mod):

    def _A_ref(q, k, v, shift_k, ssm_k, ssm_D):
        B, S, D = q.shape
        ks = shift_k.shape[-1]
        k_pad = _pad(k, ((0, 0), (ks - 1, 0), (0, 0)))
        k_shift = torch.zeros_like(k)
        for t in range(ks):
            k_shift = k_shift + k_pad[:, t:t + S, :] * shift_k[:, ks - 1 - t][None, None, :]
        kv = k_shift * v
        L = 2 * S
        kv_pad = _pad(kv, ((0, 0), (0, S), (0, 0)))
        kf_pad = _pad(ssm_k, ((0, 0), (0, S)))
        kv_f = (lambda x, axes=(-2, -1): torch.fft.rfft2(x.float(), dim=axes))(kv_pad[:, None, :, :], axes=(1, 2))
        kf_f = (lambda x, axes=(-2, -1): torch.fft.rfft2(x.float(), dim=axes))(kf_pad[:, None, :], axes=(1, 2))
        kf_f = (lambda x, *d: x.permute(*d))(kf_f, 1, 2, 0)
        y_f = kv_f * kf_f[None, :, :, :]
        y = (lambda x, s, axes=(-2, -1): torch.fft.irfft2(x, s=s, dim=axes).to(torch.bfloat16))(y_f, (1, L), axes=(1, 2))[:, 0, :S, :]
        y = y + kv * ssm_D[None, None, :]
        return q * y

    def _B_ref(x, w_gate, w_up, w_down):
        return _gelu(x @ w_gate) * (x @ w_up) @ w_down
    x = A_q
    mod = (_silu(c) @ w_mod).reshape(c.shape[0], 6, 1, -1)
    sa, ca, ga, sb, cb, gb = (mod[:, 0].clone(), mod[:, 1].clone(), mod[:, 2].clone(), mod[:, 3].clone(), mod[:, 4].clone(), mod[:, 5].clone())
    h = _layernorm(x, axis=-1) * (1 + ca) + sa
    x = x + ga * _A_ref(h, A_k, A_v, A_shift_k, A_ssm_k, A_ssm_D)
    h = _layernorm(x, axis=-1) * (1 + cb) + sb
    x = x + gb * _B_ref(h, B_w_gate, B_w_up, B_w_down)
    return x
```

```asm
; @launch grid=(224,1,1) block=(512,1,1) lds=131136
.amdgcn_target "amdgcn-amd-amdhsa--gfx950"
.text
.globl adaLN_cond__ssm_conv_h3__geglu_ffn__prompt_kernel
.p2align 8
.type adaLN_cond__ssm_conv_h3__geglu_ffn__prompt_kernel,@function
adaLN_cond__ssm_conv_h3__geglu_ffn__prompt_kernel:
    s_load_dwordx4 s[4:7], s[0:1], 0
    s_load_dwordx4 s[8:11], s[0:1], 16
    s_load_dwordx4 s[12:15], s[0:1], 80
    s_load_dwordx2 s[16:17], s[0:1], 112
    s_load_dwordx2 s[18:19], s[0:1], 72
    s_cmp_ge_u32 s2, 224
    s_cbranch_scc1 MG_END
    s_getpc_b64 s[66:67]
Lpf9:
    s_getreg_b32 s68, hwreg(HW_REG_HW_ID, 8, 4)
    s_and_b32 s68, s68, 7
    s_mul_i32 s68, s68, 3584
    v_lshlrev_b32 v248, 7, v0
    v_add_u32 v248, s68, v248
    v_min_u32 v248, CODE_END-Lpf9-4, v248
    v_cmp_gt_u32 vcc, 28, v0
    s_nop 0
    s_and_saveexec_b64 s[68:69], vcc
    global_load_dword v249, v248, s[66:67]
    s_mov_b64 exec, s[68:69]
    v_lshrrev_b32 v1, 6, v0
    s_nop 0
    v_readfirstlane_b32 s3, v1
    s_mov_b32 s50, 0x3f803f80
    s_mov_b32 s51, 0x05040100
    s_mov_b32 s52, 0x07060302
    s_waitcnt lgkmcnt(0)
    s_cmp_ge_u32 s3, 4
    s_cbranch_scc1 PA_UPPER
    s_mov_b32 s20, s4
    s_mov_b32 s21, s5
    s_mov_b32 s22, 1835008
    s_mov_b32 s23, 0x00020000
    s_mov_b32 s24, s6
    s_mov_b32 s25, s7
    s_mov_b32 s26, 1835008
    s_mov_b32 s27, 0x00020000
    s_mov_b32 s28, s8
    s_mov_b32 s29, s9
    s_mov_b32 s30, 1835008
    s_mov_b32 s31, 0x00020000
    s_mov_b32 s32, s10
    s_mov_b32 s33, s11
    s_mov_b32 s34, 3584
    s_mov_b32 s35, 0x00020000
    s_mul_i32 s45, s2, 9363
    s_lshr_b32 s45, s45, 16
    s_mul_i32 s44, s45, 7
    s_sub_u32 s44, s2, s44
    s_mov_b32 s46, 4480
    s_lshl_b32 s47, s45, 6
    v_lshrrev_b32 v5, 5, v0
    v_lshl_add_u32 v5, v5, 3, s47
    s_lshl_b32 s47, s44, 5
    v_and_b32 v6, 31, v0
    v_add_u32 v6, s47, v6
    v_mul_u32_u24 v1, 896, v5
    v_lshl_add_u32 v1, v6, 2, v1
    v_subrev_u32 v2, 2688, v1
    v_lshlrev_b32 v3, 4, v6
    buffer_load_dwordx4 v[8:11], v3, s[32:35], 0 offen
    buffer_load_dword v12, v2, s[24:27], 0 offen offset:0
    buffer_load_dword v13, v2, s[24:27], 0 offen offset:896
    buffer_load_dword v14, v2, s[24:27], 0 offen offset:1792
    buffer_load_dword v15, v1, s[24:27], 0 offen offset:0
    buffer_load_dword v16, v1, s[24:27], 0 offen offset:896
    buffer_load_dword v17, v1, s[24:27], 0 offen offset:1792
    buffer_load_dword v18, v1, s[24:27], 0 offen offset:2688
    buffer_load_dword v19, v1, s[24:27], 0 offen offset:3584
    buffer_load_dword v20, v1, s[24:27], s46 offen offset:0
    buffer_load_dword v21, v1, s[24:27], s46 offen offset:896
    buffer_load_dword v22, v1, s[24:27], s46 offen offset:1792
    buffer_load_dword v24, v1, s[28:31], 0 offen offset:0
    buffer_load_dword v25, v1, s[28:31], 0 offen offset:896
    buffer_load_dword v26, v1, s[28:31], 0 offen offset:1792
    buffer_load_dword v27, v1, s[28:31], 0 offen offset:2688
    buffer_load_dword v28, v1, s[28:31], 0 offen offset:3584
    buffer_load_dword v29, v1, s[28:31], s46 offen offset:0
    buffer_load_dword v30, v1, s[28:31], s46 offen offset:896
    buffer_load_dword v31, v1, s[28:31], s46 offen offset:1792
    buffer_load_dword v32, v1, s[20:23], 0 offen offset:0
    buffer_load_dword v33, v1, s[20:23], 0 offen offset:896
    buffer_load_dword v34, v1, s[20:23], 0 offen offset:1792
    buffer_load_dword v35, v1, s[20:23], 0 offen offset:2688
    buffer_load_dword v36, v1, s[20:23], 0 offen offset:3584
    buffer_load_dword v37, v1, s[20:23], s46 offen offset:0
    buffer_load_dword v38, v1, s[20:23], s46 offen offset:896
    buffer_load_dword v39, v1, s[20:23], s46 offen offset:1792
    s_waitcnt vmcnt(16)
    v_lshlrev_b32 v62, 16, v8
    v_lshlrev_b32 v63, 16, v10
    v_and_b32 v64, 0xffff0000, v8
    v_and_b32 v65, 0xffff0000, v10
    v_lshlrev_b32 v66, 16, v9
    v_lshlrev_b32 v67, 16, v11
    v_and_b32 v68, 0xffff0000, v9
    v_and_b32 v69, 0xffff0000, v11
    v_lshlrev_b32 v40, 16, v12
    v_and_b32 v41, 0xffff0000, v12
    v_lshlrev_b32 v42, 16, v13
    v_and_b32 v43, 0xffff0000, v13
    v_lshlrev_b32 v44, 16, v14
    v_and_b32 v45, 0xffff0000, v14
    v_lshlrev_b32 v46, 16, v15
    v_and_b32 v47, 0xffff0000, v15
    v_lshlrev_b32 v48, 16, v16
    v_and_b32 v49, 0xffff0000, v16
    v_lshlrev_b32 v50, 16, v17
    v_and_b32 v51, 0xffff0000, v17
    v_lshlrev_b32 v52, 16, v18
    v_and_b32 v53, 0xffff0000, v18
    v_lshlrev_b32 v54, 16, v19
    v_and_b32 v55, 0xffff0000, v19
    v_lshlrev_b32 v56, 16, v20
    v_and_b32 v57, 0xffff0000, v20
    v_lshlrev_b32 v58, 16, v21
    v_and_b32 v59, 0xffff0000, v21
    v_lshlrev_b32 v60, 16, v22
    v_and_b32 v61, 0xffff0000, v22
    s_waitcnt vmcnt(8)
    v_mov_b32 v252, 0
    v_mov_b32 v253, 0
    s_cmp_lg_u32 s3, 3
    s_cbranch_scc1 PA_NORD
    s_load_dwordx2 s[54:55], s[0:1], 104
    s_waitcnt lgkmcnt(0)
    s_mov_b32 s40, s54
    s_mov_b32 s41, s55
    s_mov_b32 s42, 256
    s_mov_b32 s43, 0x00020000
    buffer_load_dword v252, v253, s[40:43], 0 offen sc1
PA_NORD:
    v_mul_f32 v72, v40, v68
    v_mul_f32 v73, v41, v69
    v_cvt_pk_bf16_f32 v3, v72, v73
    v_lshlrev_b32 v72, 16, v3
    v_and_b32 v73, 0xffff0000, v3
    v_mul_f32 v70, v42, v66
    v_mul_f32 v71, v43, v67
    v_cvt_pk_bf16_f32 v4, v70, v71
    v_lshlrev_b32 v70, 16, v4
    v_and_b32 v71, 0xffff0000, v4
    v_add_f32 v72, v72, v70
    v_add_f32 v73, v73, v71
    v_cvt_pk_bf16_f32 v3, v72, v73
    v_lshlrev_b32 v72, 16, v3
    v_and_b32 v73, 0xffff0000, v3
    v_mul_f32 v70, v44, v64
    v_mul_f32 v71, v45, v65
    v_cvt_pk_bf16_f32 v4, v70, v71
    v_lshlrev_b32 v70, 16, v4
    v_and_b32 v71, 0xffff0000, v4
    v_add_f32 v72, v72, v70
    v_add_f32 v73, v73, v71
    v_cvt_pk_bf16_f32 v3, v72, v73
    v_lshlrev_b32 v72, 16, v3
    v_and_b32 v73, 0xffff0000, v3
    v_mul_f32 v70, v46, v62
    v_mul_f32 v71, v47, v63
    v_cvt_pk_bf16_f32 v4, v70, v71
    v_lshlrev_b32 v70, 16, v4
    v_and_b32 v71, 0xffff0000, v4
    v_add_f32 v72, v72, v70
    v_add_f32 v73, v73, v71
    v_cvt_pk_bf16_f32 v3, v72, v73
    v_lshlrev_b32 v72, 16, v3
    v_and_b32 v73, 0xffff0000, v3
    v_lshlrev_b32 v74, 16, v24
    v_and_b32 v75, 0xffff0000, v24
    v_mul_f32 v72, v72, v74
    v_mul_f32 v73, v73, v75
    v_cvt_pk_bf16_f32 v76, v72, v73
    v_mul_f32 v72, v42, v68
    v_mul_f32 v73, v43, v69
    v_cvt_pk_bf16_f32 v3, v72, v73
    v_lshlrev_b32 v72, 16, v3
    v_and_b32 v73, 0xffff0000, v3
    v_mul_f32 v70, v44, v66
    v_mul_f32 v71, v45, v67
    v_cvt_pk_bf16_f32 v4, v70, v71
    v_lshlrev_b32 v70, 16, v4
    v_and_b32 v71, 0xffff0000, v4
    v_add_f32 v72, v72, v70
    v_add_f32 v73, v73, v71
    v_cvt_pk_bf16_f32 v3, v72, v73
    v_lshlrev_b32 v72, 16, v3
    v_and_b32 v73, 0xffff0000, v3
    v_mul_f32 v70, v46, v64
    v_mul_f32 v71, v47, v65
    v_cvt_pk_bf16_f32 v4, v70, v71
    v_lshlrev_b32 v70, 16, v4
    v_and_b32 v71, 0xffff0000, v4
    v_add_f32 v72, v72, v70
    v_add_f32 v73, v73, v71
    v_cvt_pk_bf16_f32 v3, v72, v73
    v_lshlrev_b32 v72, 16, v3
    v_and_b32 v73, 0xffff0000, v3
    v_mul_f32 v70, v48, v62
    v_mul_f32 v71, v49, v63
    v_cvt_pk_bf16_f32 v4, v70, v71
    v_lshlrev_b32 v70, 16, v4
    v_and_b32 v71, 0xffff0000, v4
    v_add_f32 v72, v72, v70
    v_add_f32 v73, v73, v71
    v_cvt_pk_bf16_f32 v3, v72, v73
    v_lshlrev_b32 v72, 16, v3
    v_and_b32 v73, 0xffff0000, v3
    v_lshlrev_b32 v74, 16, v25
    v_and_b32 v75, 0xffff0000, v25
    v_mul_f32 v72, v72, v74
    v_mul_f32 v73, v73, v75
    v_cvt_pk_bf16_f32 v77, v72, v73
    v_mul_f32 v72, v44, v68
    v_mul_f32 v73, v45, v69
    v_cvt_pk_bf16_f32 v3, v72, v73
    v_lshlrev_b32 v72, 16, v3
    v_and_b32 v73, 0xffff0000, v3
    v_mul_f32 v70, v46, v66
    v_mul_f32 v71, v47, v67
    v_cvt_pk_bf16_f32 v4, v70, v71
    v_lshlrev_b32 v70, 16, v4
    v_and_b32 v71, 0xffff0000, v4
    v_add_f32 v72, v72, v70
    v_add_f32 v73, v73, v71
    v_cvt_pk_bf16_f32 v3, v72, v73
    v_lshlrev_b32 v72, 16, v3
    v_and_b32 v73, 0xffff0000, v3
    v_mul_f32 v70, v48, v64
    v_mul_f32 v71, v49, v65
    v_cvt_pk_bf16_f32 v4, v70, v71
    v_lshlrev_b32 v70, 16, v4
    v_and_b32 v71, 0xffff0000, v4
    v_add_f32 v72, v72, v70
    v_add_f32 v73, v73, v71
    v_cvt_pk_bf16_f32 v3, v72, v73
    v_lshlrev_b32 v72, 16, v3
    v_and_b32 v73, 0xffff0000, v3
    v_mul_f32 v70, v50, v62
    v_mul_f32 v71, v51, v63
    v_cvt_pk_bf16_f32 v4, v70, v71
    v_lshlrev_b32 v70, 16, v4
    v_and_b32 v71, 0xffff0000, v4
    v_add_f32 v72, v72, v70
    v_add_f32 v73, v73, v71
    v_cvt_pk_bf16_f32 v3, v72, v73
    v_lshlrev_b32 v72, 16, v3
    v_and_b32 v73, 0xffff0000, v3
    v_lshlrev_b32 v74, 16, v26
    v_and_b32 v75, 0xffff0000, v26
    v_mul_f32 v72, v72, v74
    v_mul_f32 v73, v73, v75
    v_cvt_pk_bf16_f32 v78, v72, v73
    v_mul_f32 v72, v46, v68
    v_mul_f32 v73, v47, v69
    v_cvt_pk_bf16_f32 v3, v72, v73
    v_lshlrev_b32 v72, 16, v3
    v_and_b32 v73, 0xffff0000, v3
    v_mul_f32 v70, v48, v66
    v_mul_f32 v71, v49, v67
    v_cvt_pk_bf16_f32 v4, v70, v71
    v_lshlrev_b32 v70, 16, v4
    v_and_b32 v71, 0xffff0000, v4
    v_add_f32 v72, v72, v70
    v_add_f32 v73, v73, v71
    v_cvt_pk_bf16_f32 v3, v72, v73
    v_lshlrev_b32 v72, 16, v3
    v_and_b32 v73, 0xffff0000, v3
    v_mul_f32 v70, v50, v64
    v_mul_f32 v71, v51, v65
    v_cvt_pk_bf16_f32 v4, v70, v71
    v_lshlrev_b32 v70, 16, v4
    v_and_b32 v71, 0xffff0000, v4
    v_add_f32 v72, v72, v70
    v_add_f32 v73, v73, v71
    v_cvt_pk_bf16_f32 v3, v72, v73
    v_lshlrev_b32 v72, 16, v3
    v_and_b32 v73, 0xffff0000, v3
    v_mul_f32 v70, v52, v62
    v_mul_f32 v71, v53, v63
    v_cvt_pk_bf16_f32 v4, v70, v71
    v_lshlrev_b32 v70, 16, v4
    v_and_b32 v71, 0xffff0000, v4
    v_add_f32 v72, v72, v70
    v_add_f32 v73, v73, v71
    v_cvt_pk_bf16_f32 v3, v72, v73
    v_lshlrev_b32 v72, 16, v3
    v_and_b32 v73, 0xffff0000, v3
    v_lshlrev_b32 v74, 16, v27
    v_and_b32 v75, 0xffff0000, v27
    v_mul_f32 v72, v72, v74
    v_mul_f32 v73, v73, v75
    v_cvt_pk_bf16_f32 v79, v72, v73
    v_mul_f32 v72, v48, v68
    v_mul_f32 v73, v49, v69
    v_cvt_pk_bf16_f32 v3, v72, v73
    v_lshlrev_b32 v72, 16, v3
    v_and_b32 v73, 0xffff0000, v3
    v_mul_f32 v70, v50, v66
    v_mul_f32 v71, v51, v67
    v_cvt_pk_bf16_f32 v4, v70, v71
    v_lshlrev_b32 v70, 16, v4
    v_and_b32 v71, 0xffff0000, v4
    v_add_f32 v72, v72, v70
    v_add_f32 v73, v73, v71
    v_cvt_pk_bf16_f32 v3, v72, v73
    v_lshlrev_b32 v72, 16, v3
    v_and_b32 v73, 0xffff0000, v3
    v_mul_f32 v70, v52, v64
    v_mul_f32 v71, v53, v65
    v_cvt_pk_bf16_f32 v4, v70, v71
    v_lshlrev_b32 v70, 16, v4
    v_and_b32 v71, 0xffff0000, v4
    v_add_f32 v72, v72, v70
    v_add_f32 v73, v73, v71
    v_cvt_pk_bf16_f32 v3, v72, v73
    v_lshlrev_b32 v72, 16, v3
    v_and_b32 v73, 0xffff0000, v3
    v_mul_f32 v70, v54, v62
    v_mul_f32 v71, v55, v63
    v_cvt_pk_bf16_f32 v4, v70, v71
    v_lshlrev_b32 v70, 16, v4
    v_and_b32 v71, 0xffff0000, v4
    v_add_f32 v72, v72, v70
    v_add_f32 v73, v73, v71
    v_cvt_pk_bf16_f32 v3, v72, v73
    v_lshlrev_b32 v72, 16, v3
    v_and_b32 v73, 0xffff0000, v3
    v_lshlrev_b32 v74, 16, v28
    v_and_b32 v75, 0xffff0000, v28
    v_mul_f32 v72, v72, v74
    v_mul_f32 v73, v73, v75
    v_cvt_pk_bf16_f32 v80, v72, v73
    v_mul_f32 v72, v50, v68
    v_mul_f32 v73, v51, v69
    v_cvt_pk_bf16_f32 v3, v72, v73
    v_lshlrev_b32 v72, 16, v3
    v_and_b32 v73, 0xffff0000, v3
    v_mul_f32 v70, v52, v66
    v_mul_f32 v71, v53, v67
    v_cvt_pk_bf16_f32 v4, v70, v71
    v_lshlrev_b32 v70, 16, v4
    v_and_b32 v71, 0xffff0000, v4
    v_add_f32 v72, v72, v70
    v_add_f32 v73, v73, v71
    v_cvt_pk_bf16_f32 v3, v72, v73
    v_lshlrev_b32 v72, 16, v3
    v_and_b32 v73, 0xffff0000, v3
    v_mul_f32 v70, v54, v64
    v_mul_f32 v71, v55, v65
    v_cvt_pk_bf16_f32 v4, v70, v71
    v_lshlrev_b32 v70, 16, v4
    v_and_b32 v71, 0xffff0000, v4
    v_add_f32 v72, v72, v70
    v_add_f32 v73, v73, v71
    v_cvt_pk_bf16_f32 v3, v72, v73
    v_lshlrev_b32 v72, 16, v3
    v_and_b32 v73, 0xffff0000, v3
    v_mul_f32 v70, v56, v62
    v_mul_f32 v71, v57, v63
    v_cvt_pk_bf16_f32 v4, v70, v71
    v_lshlrev_b32 v70, 16, v4
    v_and_b32 v71, 0xffff0000, v4
    v_add_f32 v72, v72, v70
    v_add_f32 v73, v73, v71
    v_cvt_pk_bf16_f32 v3, v72, v73
    v_lshlrev_b32 v72, 16, v3
    v_and_b32 v73, 0xffff0000, v3
    v_lshlrev_b32 v74, 16, v29
    v_and_b32 v75, 0xffff0000, v29
    v_mul_f32 v72, v72, v74
    v_mul_f32 v73, v73, v75
    v_cvt_pk_bf16_f32 v81, v72, v73
    v_mul_f32 v72, v52, v68
    v_mul_f32 v73, v53, v69
    v_cvt_pk_bf16_f32 v3, v72, v73
    v_lshlrev_b32 v72, 16, v3
    v_and_b32 v73, 0xffff0000, v3
    v_mul_f32 v70, v54, v66
    v_mul_f32 v71, v55, v67
    v_cvt_pk_bf16_f32 v4, v70, v71
    v_lshlrev_b32 v70, 16, v4
    v_and_b32 v71, 0xffff0000, v4
    v_add_f32 v72, v72, v70
    v_add_f32 v73, v73, v71
    v_cvt_pk_bf16_f32 v3, v72, v73
    v_lshlrev_b32 v72, 16, v3
    v_and_b32 v73, 0xffff0000, v3
    v_mul_f32 v70, v56, v64
    v_mul_f32 v71, v57, v65
    v_cvt_pk_bf16_f32 v4, v70, v71
    v_lshlrev_b32 v70, 16, v4
    v_and_b32 v71, 0xffff0000, v4
    v_add_f32 v72, v72, v70
    v_add_f32 v73, v73, v71
    v_cvt_pk_bf16_f32 v3, v72, v73
    v_lshlrev_b32 v72, 16, v3
    v_and_b32 v73, 0xffff0000, v3
    v_mul_f32 v70, v58, v62
    v_mul_f32 v71, v59, v63
    v_cvt_pk_bf16_f32 v4, v70, v71
    v_lshlrev_b32 v70, 16, v4
    v_and_b32 v71, 0xffff0000, v4
    v_add_f32 v72, v72, v70
    v_add_f32 v73, v73, v71
    v_cvt_pk_bf16_f32 v3, v72, v73
    v_lshlrev_b32 v72, 16, v3
    v_and_b32 v73, 0xffff0000, v3
    v_lshlrev_b32 v74, 16, v30
    v_and_b32 v75, 0xffff0000, v30
    v_mul_f32 v72, v72, v74
    v_mul_f32 v73, v73, v75
    v_cvt_pk_bf16_f32 v82, v72, v73
    v_mul_f32 v72, v54, v68
    v_mul_f32 v73, v55, v69
    v_cvt_pk_bf16_f32 v3, v72, v73
    v_lshlrev_b32 v72, 16, v3
    v_and_b32 v73, 0xffff0000, v3
    v_mul_f32 v70, v56, v66
    v_mul_f32 v71, v57, v67
    v_cvt_pk_bf16_f32 v4, v70, v71
    v_lshlrev_b32 v70, 16, v4
    v_and_b32 v71, 0xffff0000, v4
    v_add_f32 v72, v72, v70
    v_add_f32 v73, v73, v71
    v_cvt_pk_bf16_f32 v3, v72, v73
    v_lshlrev_b32 v72, 16, v3
    v_and_b32 v73, 0xffff0000, v3
    v_mul_f32 v70, v58, v64
    v_mul_f32 v71, v59, v65
    v_cvt_pk_bf16_f32 v4, v70, v71
    v_lshlrev_b32 v70, 16, v4
    v_and_b32 v71, 0xffff0000, v4
    v_add_f32 v72, v72, v70
    v_add_f32 v73, v73, v71
    v_cvt_pk_bf16_f32 v3, v72, v73
    v_lshlrev_b32 v72, 16, v3
    v_and_b32 v73, 0xffff0000, v3
    v_mul_f32 v70, v60, v62
    v_mul_f32 v71, v61, v63
    v_cvt_pk_bf16_f32 v4, v70, v71
    v_lshlrev_b32 v70, 16, v4
    v_and_b32 v71, 0xffff0000, v4
    v_add_f32 v72, v72, v70
    v_add_f32 v73, v73, v71
    v_cvt_pk_bf16_f32 v3, v72, v73
    v_lshlrev_b32 v72, 16, v3
    v_and_b32 v73, 0xffff0000, v3
    v_lshlrev_b32 v74, 16, v31
    v_and_b32 v75, 0xffff0000, v31
    v_mul_f32 v72, v72, v74
    v_mul_f32 v73, v73, v75
    v_cvt_pk_bf16_f32 v83, v72, v73
    v_perm_b32 v84, v82, v83, s51
    v_perm_b32 v88, v82, v83, s52
    v_perm_b32 v85, v80, v81, s51
    v_perm_b32 v89, v80, v81, s52
    v_perm_b32 v86, v78, v79, s51
    v_perm_b32 v90, v78, v79, s52
    v_perm_b32 v87, v76, v77, s51
    v_perm_b32 v91, v76, v77, s52
    v_and_b32 v3, 31, v0
    v_mul_u32_u24 v100, 288, v3
    v_add_u32 v100, 98304, v100
    v_lshrrev_b32 v3, 5, v0
    v_lshl_add_u32 v101, v3, 4, v100
    v_sub_u32 v3, 7, v3
    v_lshl_add_u32 v100, v3, 4, v100
    ds_write_b128 v100, v[84:87]
    ds_write_b128 v100, v[88:91] offset:144
    s_waitcnt vmcnt(0)
    v_perm_b32 v92, v33, v32, s51
    v_perm_b32 v96, v33, v32, s52
    v_perm_b32 v93, v35, v34, s51
    v_perm_b32 v97, v35, v34, s52
    v_perm_b32 v94, v37, v36, s51
    v_perm_b32 v98, v37, v36, s52
    v_perm_b32 v95, v39, v38, s51
    v_perm_b32 v99, v39, v38, s52
    ds_write_b128 v101, v[92:95] offset:9216
    ds_write_b128 v101, v[96:99] offset:9360
    s_branch PA_JOIN
PA_UPPER:
    v_and_b32 v1, 255, v0
    s_cmp_ge_u32 s2, 212
    s_cbranch_scc1 PA_IDLE
    s_cmp_ge_u32 s2, 84
    s_cbranch_scc1 PA_STAT
    s_cmp_ge_u32 s2, 10
    s_cbranch_scc1 PA_NOZ
    s_add_u32 s32, s16, 24576
    s_addc_u32 s33, s17, 0
    s_mov_b32 s34, 40960
    s_mov_b32 s35, 0x00020000
    v_mov_b32 v4, 0
    v_mov_b32 v5, 0
    v_mov_b32 v6, 0
    v_mov_b32 v7, 0
    v_lshlrev_b32 v2, 4, v1
    s_lshl_b32 s44, s2, 12
    buffer_store_dwordx4 v[4:7], v2, s[32:35], s44 offen sc1
    s_nop 1
PA_NOZ:
    s_mov_b32 s20, s12
    s_mov_b32 s21, s13
    s_mov_b32 s22, 896
    s_mov_b32 s23, 0x00020000
    s_mov_b32 s24, s14
    s_mov_b32 s25, s15
    s_mov_b32 s26, 2408448
    s_mov_b32 s27, 0x00020000
    s_lshr_b32 s44, s2, 1
    s_lshl_b32 s44, s44, 7
    s_and_b32 s45, s2, 1
    s_mul_i32 s46, s45, 1204224
    s_add_u32 s44, s44, s46
    s_mul_i32 s45, s45, 448
    v_lshrrev_b32 v5, 3, v1
    v_and_b32 v6, 7, v1
    v_mul_u32_u24 v4, 5376, v5
    v_lshl_add_u32 v4, v6, 4, v4
    v_lshlrev_b32 v2, 1, v5
    v_mov_b32 v43, 0
    buffer_load_ushort v36, v2, s[20:23], s45 offen offset:0
    buffer_load_ushort v37, v2, s[20:23], s45 offen offset:64
    buffer_load_ushort v38, v2, s[20:23], s45 offen offset:128
    buffer_load_ushort v39, v2, s[20:23], s45 offen offset:192
    buffer_load_ushort v40, v2, s[20:23], s45 offen offset:256
    buffer_load_ushort v41, v2, s[20:23], s45 offen offset:320
    buffer_load_ushort v42, v2, s[20:23], s45 offen offset:384
    buffer_load_dwordx4 v[8:11], v4, s[24:27], s44 offen
    s_add_u32 s44, s44, 172032
    buffer_load_dwordx4 v[12:15], v4, s[24:27], s44 offen
    s_add_u32 s44, s44, 172032
    buffer_load_dwordx4 v[16:19], v4, s[24:27], s44 offen
    s_add_u32 s44, s44, 172032
    buffer_load_dwordx4 v[20:23], v4, s[24:27], s44 offen
    s_add_u32 s44, s44, 172032
    buffer_load_dwordx4 v[24:27], v4, s[24:27], s44 offen
    s_add_u32 s44, s44, 172032
    buffer_load_dwordx4 v[28:31], v4, s[24:27], s44 offen
    s_add_u32 s44, s44, 172032
    buffer_load_dwordx4 v[32:35], v4, s[24:27], s44 offen
    s_waitcnt vmcnt(7)
    v_lshlrev_b32 v36, 16, v36
    v_lshlrev_b32 v37, 16, v37
    v_lshlrev_b32 v38, 16, v38
    v_lshlrev_b32 v39, 16, v39
    v_lshlrev_b32 v40, 16, v40
    v_lshlrev_b32 v41, 16, v41
    v_lshlrev_b32 v42, 16, v42
    v_mul_f32 v44, 0xbfb8aa3b, v36
    v_mul_f32 v45, 0xbfb8aa3b, v37
    v_mul_f32 v46, 0xbfb8aa3b, v38
    v_mul_f32 v47, 0xbfb8aa3b, v39
    v_mul_f32 v48, 0xbfb8aa3b, v40
    v_mul_f32 v49, 0xbfb8aa3b, v41
    v_mul_f32 v50, 0xbfb8aa3b, v42
    v_exp_f32 v44, v44
    v_exp_f32 v45, v45
    v_exp_f32 v46, v46
    v_exp_f32 v47, v47
    v_exp_f32 v48, v48
    v_exp_f32 v49, v49
    v_exp_f32 v50, v50
    v_add_f32 v44, 1.0, v44
    v_add_f32 v45, 1.0, v45
    v_add_f32 v46, 1.0, v46
    v_add_f32 v47, 1.0, v47
    v_add_f32 v48, 1.0, v48
    v_add_f32 v49, 1.0, v49
    v_add_f32 v50, 1.0, v50
    v_rcp_f32 v44, v44
    v_rcp_f32 v45, v45
    v_rcp_f32 v46, v46
    v_rcp_f32 v47, v47
    v_rcp_f32 v48, v48
    v_rcp_f32 v49, v49
    v_rcp_f32 v50, v50
    v_mul_f32 v36, v36, v44
    v_mul_f32 v37, v37, v45
    v_mul_f32 v38, v38, v46
    v_mul_f32 v39, v39, v47
    v_mul_f32 v40, v40, v48
    v_mul_f32 v41, v41, v49
    v_mul_f32 v42, v42, v50
    v_cvt_pk_bf16_f32 v2, v36, v37
    v_lshlrev_b32 v36, 16, v2
    v_and_b32 v37, 0xffff0000, v2
    v_cvt_pk_bf16_f32 v2, v38, v39
    v_lshlrev_b32 v38, 16, v2
    v_and_b32 v39, 0xffff0000, v2
    v_cvt_pk_bf16_f32 v2, v40, v41
    v_lshlrev_b32 v40, 16, v2
    v_and_b32 v41, 0xffff0000, v2
    v_cvt_pk_bf16_f32 v2, v42, v43
    v_lshlrev_b32 v42, 16, v2
    v_and_b32 v43, 0xffff0000, v2
    v_mov_b32 v52, 0
    v_mov_b32 v53, 0
    v_mov_b32 v54, 0
    v_mov_b32 v55, 0
    v_mov_b32 v56, 0
    v_mov_b32 v57, 0
    v_mov_b32 v58, 0
    v_mov_b32 v59, 0
    s_waitcnt vmcnt(6)
    v_lshlrev_b32 v60, 16, v8
    v_and_b32 v61, 0xffff0000, v8
    v_fmac_f32 v52, v60, v36
    v_fmac_f32 v53, v61, v36
    v_lshlrev_b32 v60, 16, v9
    v_and_b32 v61, 0xffff0000, v9
    v_fmac_f32 v54, v60, v36
    v_fmac_f32 v55, v61, v36
    v_lshlrev_b32 v60, 16, v10
    v_and_b32 v61, 0xffff0000, v10
    v_fmac_f32 v56, v60, v36
    v_fmac_f32 v57, v61, v36
    v_lshlrev_b32 v60, 16, v11
    v_and_b32 v61, 0xffff0000, v11
    v_fmac_f32 v58, v60, v36
    v_fmac_f32 v59, v61, v36
    s_waitcnt vmcnt(5)
    v_lshlrev_b32 v60, 16, v12
    v_and_b32 v61, 0xffff0000, v12
    v_fmac_f32 v52, v60, v37
    v_fmac_f32 v53, v61, v37
    v_lshlrev_b32 v60, 16, v13
    v_and_b32 v61, 0xffff0000, v13
    v_fmac_f32 v54, v60, v37
    v_fmac_f32 v55, v61, v37
    v_lshlrev_b32 v60, 16, v14
    v_and_b32 v61, 0xffff0000, v14
    v_fmac_f32 v56, v60, v37
    v_fmac_f32 v57, v61, v37
    v_lshlrev_b32 v60, 16, v15
    v_and_b32 v61, 0xffff0000, v15
    v_fmac_f32 v58, v60, v37
    v_fmac_f32 v59, v61, v37
    s_waitcnt vmcnt(4)
    v_lshlrev_b32 v60, 16, v16
    v_and_b32 v61, 0xffff0000, v16
    v_fmac_f32 v52, v60, v38
    v_fmac_f32 v53, v61, v38
    v_lshlrev_b32 v60, 16, v17
    v_and_b32 v61, 0xffff0000, v17
    v_fmac_f32 v54, v60, v38
    v_fmac_f32 v55, v61, v38
    v_lshlrev_b32 v60, 16, v18
    v_and_b32 v61, 0xffff0000, v18
    v_fmac_f32 v56, v60, v38
    v_fmac_f32 v57, v61, v38
    v_lshlrev_b32 v60, 16, v19
    v_and_b32 v61, 0xffff0000, v19
    v_fmac_f32 v58, v60, v38
    v_fmac_f32 v59, v61, v38
    s_waitcnt vmcnt(3)
    v_lshlrev_b32 v60, 16, v20
    v_and_b32 v61, 0xffff0000, v20
    v_fmac_f32 v52, v60, v39
    v_fmac_f32 v53, v61, v39
    v_lshlrev_b32 v60, 16, v21
    v_and_b32 v61, 0xffff0000, v21
    v_fmac_f32 v54, v60, v39
    v_fmac_f32 v55, v61, v39
    v_lshlrev_b32 v60, 16, v22
    v_and_b32 v61, 0xffff0000, v22
    v_fmac_f32 v56, v60, v39
    v_fmac_f32 v57, v61, v39
    v_lshlrev_b32 v60, 16, v23
    v_and_b32 v61, 0xffff0000, v23
    v_fmac_f32 v58, v60, v39
    v_fmac_f32 v59, v61, v39
    s_waitcnt vmcnt(2)
    v_lshlrev_b32 v60, 16, v24
    v_and_b32 v61, 0xffff0000, v24
    v_fmac_f32 v52, v60, v40
    v_fmac_f32 v53, v61, v40
    v_lshlrev_b32 v60, 16, v25
    v_and_b32 v61, 0xffff0000, v25
    v_fmac_f32 v54, v60, v40
    v_fmac_f32 v55, v61, v40
    v_lshlrev_b32 v60, 16, v26
    v_and_b32 v61, 0xffff0000, v26
    v_fmac_f32 v56, v60, v40
    v_fmac_f32 v57, v61, v40
    v_lshlrev_b32 v60, 16, v27
    v_and_b32 v61, 0xffff0000, v27
    v_fmac_f32 v58, v60, v40
    v_fmac_f32 v59, v61, v40
    s_waitcnt vmcnt(1)
    v_lshlrev_b32 v60, 16, v28
    v_and_b32 v61, 0xffff0000, v28
    v_fmac_f32 v52, v60, v41
    v_fmac_f32 v53, v61, v41
    v_lshlrev_b32 v60, 16, v29
    v_and_b32 v61, 0xffff0000, v29
    v_fmac_f32 v54, v60, v41
    v_fmac_f32 v55, v61, v41
    v_lshlrev_b32 v60, 16, v30
    v_and_b32 v61, 0xffff0000, v30
    v_fmac_f32 v56, v60, v41
    v_fmac_f32 v57, v61, v41
    v_lshlrev_b32 v60, 16, v31
    v_and_b32 v61, 0xffff0000, v31
    v_fmac_f32 v58, v60, v41
    v_fmac_f32 v59, v61, v41
    s_waitcnt vmcnt(0)
    v_lshlrev_b32 v60, 16, v32
    v_and_b32 v61, 0xffff0000, v32
    v_fmac_f32 v52, v60, v42
    v_fmac_f32 v53, v61, v42
    v_lshlrev_b32 v60, 16, v33
    v_and_b32 v61, 0xffff0000, v33
    v_fmac_f32 v54, v60, v42
    v_fmac_f32 v55, v61, v42
    v_lshlrev_b32 v60, 16, v34
    v_and_b32 v61, 0xffff0000, v34
    v_fmac_f32 v56, v60, v42
    v_fmac_f32 v57, v61, v42
    v_lshlrev_b32 v60, 16, v35
    v_and_b32 v61, 0xffff0000, v35
    v_fmac_f32 v58, v60, v42
    v_fmac_f32 v59, v61, v42
    v_add_f32_dpp v52, v52, v52 row_shr:8 row_mask:0xf bank_mask:0xf
    v_add_f32_dpp v53, v53, v53 row_shr:8 row_mask:0xf bank_mask:0xf
    v_add_f32_dpp v54, v54, v54 row_shr:8 row_mask:0xf bank_mask:0xf
    v_add_f32_dpp v55, v55, v55 row_shr:8 row_mask:0xf bank_mask:0xf
    v_add_f32_dpp v56, v56, v56 row_shr:8 row_mask:0xf bank_mask:0xf
    v_add_f32_dpp v57, v57, v57 row_shr:8 row_mask:0xf bank_mask:0xf
    v_add_f32_dpp v58, v58, v58 row_shr:8 row_mask:0xf bank_mask:0xf
    v_add_f32_dpp v59, v59, v59 row_shr:8 row_mask:0xf bank_mask:0xf
    v_lshrrev_b32 v2, 4, v1
    v_lshlrev_b32 v2, 8, v2
    v_lshl_add_u32 v2, v6, 5, v2
    v_add_u32 v2, 116736, v2
    v_and_b32 v3, 8, v1
    v_cmp_eq_u32 vcc, 8, v3
    s_nop 0
    s_and_saveexec_b64 s[48:49], vcc
    ds_write_b128 v2, v[52:55]
    ds_write_b128 v2, v[56:59] offset:16
    s_mov_b64 exec, s[48:49]
    s_branch PA_JOIN
PA_STAT:
    s_mov_b32 s20, s4
    s_mov_b32 s21, s5
    s_mov_b32 s22, 1835008
    s_mov_b32 s23, 0x00020000
    s_add_u32 s24, s16, 2031616
    s_addc_u32 s25, s17, 0
    s_mov_b32 s26, 16384
    s_mov_b32 s27, 0x00020000
    s_sub_u32 s44, s2, 84
    s_lshl_b32 s44, s44, 4
    v_lshrrev_b32 v2, 6, v1
    v_lshl_add_u32 v2, v2, 2, s44
    v_and_b32 v3, 63, v1
    v_mul_u32_u24 v4, 896, v2
    v_lshl_add_u32 v4, v3, 4, v4
    v_mov_b32 v8, 0
    v_mov_b32 v9, 0
    v_mov_b32 v10, 0
    v_mov_b32 v11, 0
    v_mov_b32 v12, 0
    v_mov_b32 v13, 0
    v_mov_b32 v14, 0
    v_mov_b32 v15, 0
    v_mov_b32 v16, 0
    v_mov_b32 v17, 0
    v_mov_b32 v18, 0
    v_mov_b32 v19, 0
    v_mov_b32 v20, 0
    v_mov_b32 v21, 0
    v_mov_b32 v22, 0
    v_mov_b32 v23, 0
    v_cmp_gt_u32 vcc, 56, v3
    s_nop 0
    s_and_saveexec_b64 s[48:49], vcc
    buffer_load_dwordx4 v[8:11], v4, s[20:23], 0 offen offset:0
    buffer_load_dwordx4 v[12:15], v4, s[20:23], 0 offen offset:896
    buffer_load_dwordx4 v[16:19], v4, s[20:23], 0 offen offset:1792
    buffer_load_dwordx4 v[20:23], v4, s[20:23], 0 offen offset:2688
    s_mov_b64 exec, s[48:49]
    s_waitcnt vmcnt(3)
    v_dot2_f32_bf16 v24, v8, s50, 0
    v_dot2_f32_bf16 v25, v8, v8, 0
    v_dot2_f32_bf16 v24, v9, s50, v24
    v_dot2_f32_bf16 v25, v9, v9, v25
    v_dot2_f32_bf16 v24, v10, s50, v24
    v_dot2_f32_bf16 v25, v10, v10, v25
    v_dot2_f32_bf16 v24, v11, s50, v24
    v_dot2_f32_bf16 v25, v11, v11, v25
    s_waitcnt vmcnt(2)
    v_dot2_f32_bf16 v26, v12, s50, 0
    v_dot2_f32_bf16 v27, v12, v12, 0
    v_dot2_f32_bf16 v26, v13, s50, v26
    v_dot2_f32_bf16 v27, v13, v13, v27
    v_dot2_f32_bf16 v26, v14, s50, v26
    v_dot2_f32_bf16 v27, v14, v14, v27
    v_dot2_f32_bf16 v26, v15, s50, v26
    v_dot2_f32_bf16 v27, v15, v15, v27
    s_waitcnt vmcnt(1)
    v_dot2_f32_bf16 v28, v16, s50, 0
    v_dot2_f32_bf16 v29, v16, v16, 0
    v_dot2_f32_bf16 v28, v17, s50, v28
    v_dot2_f32_bf16 v29, v17, v17, v29
    v_dot2_f32_bf16 v28, v18, s50, v28
    v_dot2_f32_bf16 v29, v18, v18, v29
    v_dot2_f32_bf16 v28, v19, s50, v28
    v_dot2_f32_bf16 v29, v19, v19, v29
    s_waitcnt vmcnt(0)
    v_dot2_f32_bf16 v30, v20, s50, 0
    v_dot2_f32_bf16 v31, v20, v20, 0
    v_dot2_f32_bf16 v30, v21, s50, v30
    v_dot2_f32_bf16 v31, v21, v21, v31
    v_dot2_f32_bf16 v30, v22, s50, v30
    v_dot2_f32_bf16 v31, v22, v22, v31
    v_dot2_f32_bf16 v30, v23, s50, v30
    v_dot2_f32_bf16 v31, v23, v23, v31
    v_add_f32_dpp v24, v24, v24 row_shr:1 row_mask:0xf bank_mask:0xf
    v_add_f32_dpp v25, v25, v25 row_shr:1 row_mask:0xf bank_mask:0xf
    v_add_f32_dpp v26, v26, v26 row_shr:1 row_mask:0xf bank_mask:0xf
    v_add_f32_dpp v27, v27, v27 row_shr:1 row_mask:0xf bank_mask:0xf
    v_add_f32_dpp v28, v28, v28 row_shr:1 row_mask:0xf bank_mask:0xf
    v_add_f32_dpp v29, v29, v29 row_shr:1 row_mask:0xf bank_mask:0xf
    v_add_f32_dpp v30, v30, v30 row_shr:1 row_mask:0xf bank_mask:0xf
    v_add_f32_dpp v31, v31, v31 row_shr:1 row_mask:0xf bank_mask:0xf
    v_add_f32_dpp v24, v24, v24 row_shr:2 row_mask:0xf bank_mask:0xf
    v_add_f32_dpp v25, v25, v25 row_shr:2 row_mask:0xf bank_mask:0xf
    v_add_f32_dpp v26, v26, v26 row_shr:2 row_mask:0xf bank_mask:0xf
    v_add_f32_dpp v27, v27, v27 row_shr:2 row_mask:0xf bank_mask:0xf
    v_add_f32_dpp v28, v28, v28 row_shr:2 row_mask:0xf bank_mask:0xf
    v_add_f32_dpp v29, v29, v29 row_shr:2 row_mask:0xf bank_mask:0xf
    v_add_f32_dpp v30, v30, v30 row_shr:2 row_mask:0xf bank_mask:0xf
    v_add_f32_dpp v31, v31, v31 row_shr:2 row_mask:0xf bank_mask:0xf
    v_add_f32_dpp v24, v24, v24 row_shr:4 row_mask:0xf bank_mask:0xf
    v_add_f32_dpp v25, v25, v25 row_shr:4 row_mask:0xf bank_mask:0xf
    v_add_f32_dpp v26, v26, v26 row_shr:4 row_mask:0xf bank_mask:0xf
    v_add_f32_dpp v27, v27, v27 row_shr:4 row_mask:0xf bank_mask:0xf
    v_add_f32_dpp v28, v28, v28 row_shr:4 row_mask:0xf bank_mask:0xf
    v_add_f32_dpp v29, v29, v29 row_shr:4 row_mask:0xf bank_mask:0xf
    v_add_f32_dpp v30, v30, v30 row_shr:4 row_mask:0xf bank_mask:0xf
    v_add_f32_dpp v31, v31, v31 row_shr:4 row_mask:0xf bank_mask:0xf
    v_add_f32_dpp v24, v24, v24 row_shr:8 row_mask:0xf bank_mask:0xf
    v_add_f32_dpp v25, v25, v25 row_shr:8 row_mask:0xf bank_mask:0xf
    v_add_f32_dpp v26, v26, v26 row_shr:8 row_mask:0xf bank_mask:0xf
    v_add_f32_dpp v27, v27, v27 row_shr:8 row_mask:0xf bank_mask:0xf
    v_add_f32_dpp v28, v28, v28 row_shr:8 row_mask:0xf bank_mask:0xf
    v_add_f32_dpp v29, v29, v29 row_shr:8 row_mask:0xf bank_mask:0xf
    v_add_f32_dpp v30, v30, v30 row_shr:8 row_mask:0xf bank_mask:0xf
    v_add_f32_dpp v31, v31, v31 row_shr:8 row_mask:0xf bank_mask:0xf
    v_add_f32_dpp v24, v24, v24 row_bcast:15 row_mask:0xa bank_mask:0xf
    v_add_f32_dpp v25, v25, v25 row_bcast:15 row_mask:0xa bank_mask:0xf
    v_add_f32_dpp v26, v26, v26 row_bcast:15 row_mask:0xa bank_mask:0xf
    v_add_f32_dpp v27, v27, v27 row_bcast:15 row_mask:0xa bank_mask:0xf
    v_add_f32_dpp v28, v28, v28 row_bcast:15 row_mask:0xa bank_mask:0xf
    v_add_f32_dpp v29, v29, v29 row_bcast:15 row_mask:0xa bank_mask:0xf
    v_add_f32_dpp v30, v30, v30 row_bcast:15 row_mask:0xa bank_mask:0xf
    v_add_f32_dpp v31, v31, v31 row_bcast:15 row_mask:0xa bank_mask:0xf
    v_add_f32_dpp v24, v24, v24 row_bcast:31 row_mask:0xc bank_mask:0xf
    v_add_f32_dpp v25, v25, v25 row_bcast:31 row_mask:0xc bank_mask:0xf
    v_add_f32_dpp v26, v26, v26 row_bcast:31 row_mask:0xc bank_mask:0xf
    v_add_f32_dpp v27, v27, v27 row_bcast:31 row_mask:0xc bank_mask:0xf
    v_add_f32_dpp v28, v28, v28 row_bcast:31 row_mask:0xc bank_mask:0xf
    v_add_f32_dpp v29, v29, v29 row_bcast:31 row_mask:0xc bank_mask:0xf
    v_add_f32_dpp v30, v30, v30 row_bcast:31 row_mask:0xc bank_mask:0xf
    v_add_f32_dpp v31, v31, v31 row_bcast:31 row_mask:0xc bank_mask:0xf
    s_mov_b32 s47, 0x3b124925
    v_mul_f32 v40, s47, v24
    v_mul_f32 v41, s47, v26
    v_mul_f32 v42, s47, v25
    v_mul_f32 v43, s47, v27
    v_fma_f32 v42, -v40, v40, v42
    v_fma_f32 v43, -v41, v41, v43
    v_max_f32 v42, 0, v42
    v_max_f32 v43, 0, v43
    v_cvt_pk_bf16_f32 v3, v40, v41
    v_lshlrev_b32 v40, 16, v3
    v_and_b32 v41, 0xffff0000, v3
    v_cvt_pk_bf16_f32 v3, v42, v43
    v_lshlrev_b32 v42, 16, v3
    v_and_b32 v43, 0xffff0000, v3
    v_add_f32 v42, 0x3727c5ac, v42
    v_add_f32 v43, 0x3727c5ac, v43
    v_cvt_pk_bf16_f32 v3, v42, v43
    v_lshlrev_b32 v42, 16, v3
    v_and_b32 v43, 0xffff0000, v3
    v_sqrt_f32 v42, v42
    v_sqrt_f32 v43, v43
    s_nop 0
    v_cvt_pk_bf16_f32 v3, v42, v43
    v_lshlrev_b32 v42, 16, v3
    v_and_b32 v43, 0xffff0000, v3
    v_rcp_f32 v33, v42
    v_rcp_f32 v35, v43
    v_mov_b32 v32, v40
    v_mov_b32 v34, v41
    v_mul_f32 v40, s47, v28
    v_mul_f32 v41, s47, v30
    v_mul_f32 v42, s47, v29
    v_mul_f32 v43, s47, v31
    v_fma_f32 v42, -v40, v40, v42
    v_fma_f32 v43, -v41, v41, v43
    v_max_f32 v42, 0, v42
    v_max_f32 v43, 0, v43
    v_cvt_pk_bf16_f32 v3, v40, v41
    v_lshlrev_b32 v40, 16, v3
    v_and_b32 v41, 0xffff0000, v3
    v_cvt_pk_bf16_f32 v3, v42, v43
    v_lshlrev_b32 v42, 16, v3
    v_and_b32 v43, 0xffff0000, v3
    v_add_f32 v42, 0x3727c5ac, v42
    v_add_f32 v43, 0x3727c5ac, v43
    v_cvt_pk_bf16_f32 v3, v42, v43
    v_lshlrev_b32 v42, 16, v3
    v_and_b32 v43, 0xffff0000, v3
    v_sqrt_f32 v42, v42
    v_sqrt_f32 v43, v43
    s_nop 0
    v_cvt_pk_bf16_f32 v3, v42, v43
    v_lshlrev_b32 v42, 16, v3
    v_and_b32 v43, 0xffff0000, v3
    v_rcp_f32 v37, v42
    v_rcp_f32 v39, v43
    v_mov_b32 v36, v40
    v_mov_b32 v38, v41
    v_lshlrev_b32 v2, 3, v2
    s_mov_b32 exec_lo, 0
    s_mov_b32 exec_hi, 0x80000000
    buffer_store_dwordx4 v[32:35], v2, s[24:27], 0 offen offset:0 sc1
    buffer_store_dwordx4 v[36:39], v2, s[24:27], 0 offen offset:16 sc1
    s_mov_b64 exec, -1
    s_branch PA_JOIN
PA_IDLE:
    s_cmp_lg_u32 s2, 223
    s_cbranch_scc1 S1I_SKIP
    s_cmp_lg_u32 s3, 7
    s_cbranch_scc1 S1I_SKIP
    s_load_dwordx2 s[54:55], s[0:1], 104
    s_waitcnt lgkmcnt(0)
    s_mov_b32 s28, s54
    s_mov_b32 s29, s55
    s_mov_b32 s30, 256
    s_mov_b32 s31, 0x00020000
    s_add_u32 s24, s16, 2064384
    s_addc_u32 s25, s17, 0
    s_mov_b32 s26, 30848
    s_mov_b32 s27, 0x00020000
    v_and_b32 v252, 63, v0
    v_lshlrev_b32 v252, 4, v252
    v_mov_b32 v248, 0
    v_mov_b32 v249, 0
    v_mov_b32 v250, 0
    v_mov_b32 v251, 0
    v_mov_b32 v253, 0
    buffer_store_dwordx4 v[248:251], v252, s[24:27], 0 offen sc1
    s_waitcnt vmcnt(0)
    s_mov_b64 exec, 1
    v_mov_b32 v252, 1
    buffer_store_dword v252, v253, s[28:31], 0 offen sc1
    s_mov_b64 exec, -1
S1I_SKIP:
PA_JOIN:
    s_load_dwordx2 s[54:55], s[0:1], 104
    s_waitcnt lgkmcnt(0)
    s_mov_b32 s28, s54
    s_mov_b32 s29, s55
    s_mov_b32 s30, 256
    s_mov_b32 s31, 0x00020000
    v_mov_b32 v253, 0
    s_cmp_lg_u32 s3, 3
    s_cbranch_scc1 S1_RDY
    s_mov_b32 s65, 0
    v_readfirstlane_b32 s64, v252
    s_nop 0
    s_cmp_eq_u32 s64, 1
    s_cbranch_scc1 S1_RDY
S1_RL:
    buffer_load_dword v252, v253, s[28:31], 0 offen sc1
    s_add_u32 s65, s65, 1
    s_waitcnt vmcnt(0)
    v_readfirstlane_b32 s64, v252
    s_cmp_ge_u32 s65, 0x40000
    s_cbranch_scc1 S1_RDY
    s_cmp_lg_u32 s64, 1
    s_cbranch_scc1 S1_RL
S1_RDY:
    s_waitcnt lgkmcnt(0)
    s_barrier
    s_add_u32 s36, s16, 65536
    s_addc_u32 s37, s17, 0
    s_mov_b32 s38, 1892352
    s_mov_b32 s39, 0x00020000
    s_add_u32 s40, s16, 2097152
    s_addc_u32 s41, s17, 0
    s_mov_b32 s42, 1892352
    s_mov_b32 s43, 0x00020000
    s_mul_i32 s45, s2, 9363
    s_lshr_b32 s45, s45, 16
    s_mul_i32 s44, s45, 7
    s_sub_u32 s44, s2, s44
    v_and_b32 v1, 255, v0
    v_lshrrev_b32 v2, 3, v1
    v_and_b32 v3, 7, v1
    v_mul_u32_u24 v4, 144, v2
    v_lshl_add_u32 v4, v3, 4, v4
    s_lshr_b32 s47, s3, 2
    s_mul_i32 s48, s47, 9216
    s_add_u32 s48, s48, 98304
    v_add_u32 v4, s48, v4
    ds_read_b128 v[8:11], v4
    ds_read_b128 v[12:15], v4 offset:4608
    v_mul_u32_u24 v5, 4224, v2
    v_lshl_add_u32 v5, v3, 4, v5
    s_mul_i32 s48, s44, 270336
    s_lshl_b32 s49, s45, 7
    s_sub_u32 s46, 3968, s49
    s_cmp_eq_u32 s47, 0
    s_cselect_b32 s49, s46, s49
    s_add_u32 s48, s48, s49
    s_add_u32 s49, s48, 135168
    s_cmp_eq_u32 s47, 0
    s_cbranch_scc0 PA_STX
    s_waitcnt lgkmcnt(0)
    buffer_store_dwordx4 v[8:11], v5, s[36:39], s48 offen sc1
    buffer_store_dwordx4 v[12:15], v5, s[36:39], s49 offen sc1
    s_branch PA_STD
PA_STX:
    s_waitcnt lgkmcnt(0)
    buffer_store_dwordx4 v[8:11], v5, s[40:43], s48 offen sc1
    buffer_store_dwordx4 v[12:15], v5, s[40:43], s49 offen sc1
PA_STD:
    s_cmp_ge_u32 s2, 84
    s_cbranch_scc1 PA_NOM
    s_cmp_lg_u32 s3, 4
    s_cbranch_scc1 PA_NOM
    s_mov_b32 s28, s16
    s_mov_b32 s29, s17
    s_mov_b32 s30, 21504
    s_mov_b32 s31, 0x00020000
    v_lshlrev_b32 v2, 2, v1
    v_add_u32 v3, 116736, v2
    ds_read_b32 v16, v3 offset:0
    ds_read_b32 v17, v3 offset:256
    ds_read_b32 v18, v3 offset:512
    ds_read_b32 v19, v3 offset:768
    ds_read_b32 v20, v3 offset:1024
    ds_read_b32 v21, v3 offset:1280
    ds_read_b32 v22, v3 offset:1536
    ds_read_b32 v23, v3 offset:1792
    ds_read_b32 v24, v3 offset:2048
    ds_read_b32 v25, v3 offset:2304
    ds_read_b32 v26, v3 offset:2560
    ds_read_b32 v27, v3 offset:2816
    ds_read_b32 v28, v3 offset:3072
    ds_read_b32 v29, v3 offset:3328
    ds_read_b32 v30, v3 offset:3584
    ds_read_b32 v31, v3 offset:3840
    s_waitcnt lgkmcnt(0)
    v_add_f32 v16, v16, v24
    v_add_f32 v17, v17, v25
    v_add_f32 v18, v18, v26
    v_add_f32 v19, v19, v27
    v_add_f32 v20, v20, v28
    v_add_f32 v21, v21, v29
    v_add_f32 v22, v22, v30
    v_add_f32 v23, v23, v31
    v_add_f32 v16, v16, v20
    v_add_f32 v17, v17, v21
    v_add_f32 v18, v18, v22
    v_add_f32 v19, v19, v23
    v_add_f32 v16, v16, v18
    v_add_f32 v17, v17, v19
    v_add_f32 v16, v16, v17
    s_lshr_b32 s44, s2, 1
    s_lshl_b32 s44, s44, 8
    s_and_b32 s45, s2, 1
    s_mul_i32 s45, s45, 10752
    s_add_u32 s44, s44, s45
    buffer_store_dword v16, v2, s[28:31], s44 offen sc1
PA_NOM:
    s_add_u32 s24, s16, 2064384
    s_addc_u32 s25, s17, 0
    s_mov_b32 s26, 30848
    s_mov_b32 s27, 0x00020000
    s_load_dwordx2 s[54:55], s[0:1], 104
    s_waitcnt lgkmcnt(0)
    s_mov_b32 s28, s54
    s_mov_b32 s29, s55
    s_mov_b32 s30, 256
    s_mov_b32 s31, 0x00020000
    s_add_u32 s92, s16, 2064384
    s_addc_u32 s93, s17, 0
    s_mov_b32 s94, 30848
    s_mov_b32 s95, 0x00020000
    v_mov_b32 v253, 0
    s_waitcnt vmcnt(0) lgkmcnt(0)
    s_barrier
    s_cmp_lg_u32 s3, 7
    s_cbranch_scc1 S1_NOA
    s_mov_b64 exec, 1
    v_mov_b32 v252, 1
    s_lshl_b32 s64, s2, 2
    buffer_store_dword v252, v253, s[24:27], s64 offen sc1
S1_NOL:
    s_mov_b64 exec, -1
S1_NOA:
    s_load_dwordx2 s[4:5], s[0:1], 32
    s_lshr_b32 s44, s3, 2
    s_lshl_b32 s46, s2, 1
    s_add_u32 s46, s46, s44
    v_and_b32 v240, 255, v0
    v_lshlrev_b32 v240, 4, v240
    v_subrev_u32 v241, 16, v240
    s_waitcnt lgkmcnt(0)
    s_mul_i32 s47, s46, 4096
    s_add_u32 s47, s47, 0
    s_add_u32 s20, s4, s47
    s_addc_u32 s21, s5, 0
    s_mov_b32 s22, 4096
    s_mov_b32 s23, 0x00020000
    buffer_load_dwordx4 v[224:227], v241, s[20:23], 0 offen
    buffer_load_dwordx4 v[228:231], v240, s[20:23], 0 offen
    s_cmp_eq_u32 s3, 7
    s_cbranch_scc1 EL_SKIP
    s_load_dwordx4 s[8:11], s[0:1], 56
    s_cmp_ge_u32 s2, 112
    s_cselect_b32 s60, 112, 0
    s_sub_u32 s61, s2, s60
    s_and_b32 s49, s61, 3
    s_lshr_b32 s61, s61, 2
    v_lshrrev_b32 v242, 5, v0
    s_mul_i32 s47, s49, 14
    v_add_u32 v242, s47, v242
    v_mul_u32_u24 v242, 28672, v242
    v_and_b32 v243, 31, v0
    v_lshl_add_u32 v242, v243, 2, v242
    s_waitcnt lgkmcnt(0)
    s_cmp_ge_u32 s2, 112
    s_cselect_b32 s54, s10, s8
    s_cselect_b32 s55, s11, s9
    s_mov_b32 s32, s54
    s_mov_b32 s33, s55
    s_mov_b32 s34, 1605632
    s_mov_b32 s35, 0x00020000
    s_lshl_b32 s47, s61, 7
    buffer_load_dword v232, v242, s[32:35], s47 offen
    s_add_u32 s47, s47, 3584
    buffer_load_dword v233, v242, s[32:35], s47 offen
    s_add_u32 s47, s47, 3584
    buffer_load_dword v234, v242, s[32:35], s47 offen
    s_add_u32 s47, s47, 3584
    buffer_load_dword v235, v242, s[32:35], s47 offen
    s_add_u32 s47, s47, 3584
    buffer_load_dword v236, v242, s[32:35], s47 offen
    s_add_u32 s47, s47, 3584
    buffer_load_dword v237, v242, s[32:35], s47 offen
    s_add_u32 s47, s47, 3584
    buffer_load_dword v238, v242, s[32:35], s47 offen
    s_add_u32 s47, s47, 3584
    buffer_load_dword v239, v242, s[32:35], s47 offen
EL_SKIP:
    s_getpc_b64 s[66:67]
Lpf1165:
    s_getreg_b32 s68, hwreg(HW_REG_HW_ID, 8, 4)
    s_and_b32 s68, s68, 7
    s_mul_i32 s68, s68, 3072
    v_lshlrev_b32 v248, 7, v0
    v_add_u32 v248, s68, v248
    v_min_u32 v248, CODE_END-Lpf1165-4, v248
    v_cmp_gt_u32 vcc, 24, v0
    s_nop 0
    s_and_saveexec_b64 s[68:69], vcc
    global_load_dword v249, v248, s[66:67]
    s_mov_b64 exec, s[68:69]
    s_load_dwordx4 s[4:7], s[0:1], 32
    s_load_dwordx4 s[8:11], s[0:1], 56
    s_load_dwordx2 s[14:15], s[0:1], 96
    s_lshr_b32 s44, s3, 2
    s_bfe_u32 s45, s3, 0x10001
    s_and_b32 s53, s3, 1
    s_lshl_b32 s46, s2, 1
    s_add_u32 s46, s46, s44
    s_mul_i32 s48, s44, 40880
    s_waitcnt lgkmcnt(0)
    s_add_u32 s40, s16, 24576
    s_addc_u32 s41, s17, 0
    s_mov_b32 s42, 12288
    s_mov_b32 s43, 0x00020000
    s_lshl_b32 s47, s2, 2
    s_add_u32 s54, s6, s47
    s_addc_u32 s55, s7, 0
    s_load_dword s59, s[54:55], 0
    v_and_b32 v1, 255, v0
    v_and_b32 v2, 63, v0
    v_and_b32 v5, 31, v0
    v_bfe_u32 v6, v0, 5, 1
    s_cmp_ge_u32 s2, 112
    s_cselect_b32 s60, 1, 0
    s_cselect_b32 s54, s10, s8
    s_cselect_b32 s55, s11, s9
    s_mul_i32 s61, s60, 112
    s_sub_u32 s61, s2, s61
    s_and_b32 s49, s61, 3
    s_lshr_b32 s61, s61, 2
    s_mov_b32 s32, s54
    s_mov_b32 s33, s55
    s_mov_b32 s34, 1605632
    s_mov_b32 s35, 0x00020000
    v_and_b32 v64, 31, v0
    v_lshrrev_b32 v65, 5, v0
    v_min_u32 v65, 13, v65
    s_mul_i32 s47, s49, 14
    v_add_u32 v65, s47, v65
    v_mov_b32 v84, 0
    v_mov_b32 v85, 0
    v_mov_b32 v86, 0
    v_mov_b32 v87, 0
    v_lshrrev_b32 v3, 2, v1
    v_mul_u32_u24 v3, 4160, v3
    v_and_b32 v4, 3, v1
    v_lshl_add_u32 v3, v4, 4, v3
    v_add_u32 v3, s48, v3
    v_cmp_gt_u32 vcc, 32, v1
    v_cmp_ne_u32 s[62:63], 3, v4
    s_nop 0
    s_and_b64 vcc, vcc, s[62:63]
    s_and_saveexec_b64 s[62:63], vcc
    ds_write_b128 v3, v[84:87]
    s_mov_b64 exec, s[62:63]
    v_lshrrev_b32 v3, 2, v1
    v_mul_u32_u24 v3, 80, v3
    v_lshl_add_u32 v3, v4, 4, v3
    v_add_u32 v3, s48, v3
    v_mov_b32 v88, v3
    v_cmp_gt_u32 vcc, 124, v1
    s_nop 0
    s_and_saveexec_b64 s[62:63], vcc
    ds_write_b128 v3, v[84:87] offset:38400
    s_mov_b64 exec, s[62:63]
    v_lshlrev_b32 v89, 4, v1
    v_add_u32 v89, s48, v89
    s_waitcnt vmcnt(8)
    s_cmp_lg_u32 s3, 7
    s_cbranch_scc1 MG_E7
    s_waitcnt vmcnt(0)
MG_E7:
    ds_write_b128 v89, v[226:229] offset:12528
    ds_write_b128 v89, v[228:231] offset:29168
    v_alignbit_b32 v50, v225, v224, 16
    v_alignbit_b32 v51, v226, v225, 16
    v_alignbit_b32 v52, v227, v226, 16
    v_alignbit_b32 v53, v228, v227, 16
    v_alignbit_b32 v54, v229, v228, 16
    v_alignbit_b32 v55, v230, v229, 16
    ds_write_b128 v89, v[50:53] offset:48
    ds_write_b128 v89, v[52:55] offset:16688
    v_alignbit_b32 v56, v226, v225, 16
    v_alignbit_b32 v57, v227, v226, 16
    v_alignbit_b32 v58, v228, v227, 16
    v_alignbit_b32 v59, v229, v228, 16
    v_alignbit_b32 v60, v230, v229, 16
    v_alignbit_b32 v61, v231, v230, 16
    ds_write_b128 v89, v[56:59] offset:8368
    ds_write_b128 v89, v[58:61] offset:25008
    v_mov_b32 v44, v225
    v_mov_b32 v45, v226
    v_mov_b32 v46, v227
    v_mov_b32 v47, v228
    v_mov_b32 v48, v229
    v_mov_b32 v49, v230
    ds_write_b128 v89, v[44:47] offset:4208
    ds_write_b128 v89, v[46:49] offset:20848
    s_xor_b32 s47, s45, 1
    s_lshl_b32 s47, s47, 5
    s_add_u32 s47, s47, s48
    s_lshl_b32 s49, s53, 10
    s_add_u32 s49, s49, s47
    v_and_b32 v3, 7, v5
    v_mul_u32_u24 v90, 4160, v3
    v_lshrrev_b32 v3, 3, v5
    v_add_u32 v3, v3, v6
    v_lshl_add_u32 v90, v3, 4, v90
    v_add_u32 v90, s49, v90
    s_mul_i32 s49, s53, 1280
    s_add_u32 s49, s49, s47
    v_sub_u32 v3, 31, v5
    v_mul_u32_u24 v91, 80, v3
    v_lshl_add_u32 v91, v6, 4, v91
    v_add_u32 v91, s49, v91
    v_mov_b32 v92, 0
    v_mov_b32 v93, 0
    v_mov_b32 v94, 0
    v_mov_b32 v95, 0
    v_mov_b32 v96, 0
    v_mov_b32 v97, 0
    v_mov_b32 v98, 0
    v_mov_b32 v99, 0
    v_mov_b32 v100, 0
    v_mov_b32 v101, 0
    v_mov_b32 v102, 0
    v_mov_b32 v103, 0
    v_mov_b32 v104, 0
    v_mov_b32 v105, 0
    v_mov_b32 v106, 0
    v_mov_b32 v107, 0
    v_mov_b32 v108, 0
    v_mov_b32 v109, 0
    v_mov_b32 v110, 0
    v_mov_b32 v111, 0
    v_mov_b32 v112, 0
    v_mov_b32 v113, 0
    v_mov_b32 v114, 0
    v_mov_b32 v115, 0
    v_mov_b32 v116, 0
    v_mov_b32 v117, 0
    v_mov_b32 v118, 0
    v_mov_b32 v119, 0
    v_mov_b32 v120, 0
    v_mov_b32 v121, 0
    v_mov_b32 v122, 0
    v_mov_b32 v123, 0
    s_cmp_lg_u32 s3, 7
    s_cbranch_scc1 P1AD
    s_mov_b32 exec_lo, -1
    s_mov_b32 exec_hi, 0x00ffffff
    v_and_b32 v252, 63, v0
    v_lshlrev_b32 v252, 4, v252
    s_mov_b32 s65, 0
P1AL:
    buffer_load_dwordx4 v[248:251], v252, s[92:95], 0 offen sc1
    s_add_u32 s65, s65, 1
    s_waitcnt vmcnt(0)
    v_and_b32 v248, v248, v249
    v_and_b32 v250, v250, v251
    v_and_b32 v248, v248, v250
    v_cmp_ne_u32 vcc, 1, v248
    s_cmp_ge_u32 s65, 0x40000
    s_cbranch_scc1 P1AO
    s_cbranch_vccz P1AO
    s_sleep 0
    s_branch P1AL
P1AO:
    s_mov_b64 exec, -1
P1AD:
    s_barrier
    s_mul_i32 s47, s46, 4224
    s_add_u32 s47, s47, 65536
    s_add_u32 s24, s16, s47
    s_addc_u32 s25, s17, 0
    s_mov_b32 s26, 4096
    s_mov_b32 s27, 0x00020000
    s_mul_i32 s47, s46, 4224
    s_add_u32 s47, s47, 2097152
    s_add_u32 s28, s16, s47
    s_addc_u32 s29, s17, 0
    s_mov_b32 s30, 4096
    s_mov_b32 s31, 0x00020000
    s_add_u32 s32, s16, 2031616
    s_addc_u32 s33, s17, 0
    s_mov_b32 s34, 16384
    s_mov_b32 s35, 0x00020000
    s_mov_b32 s36, s16
    s_mov_b32 s37, s17
    s_mov_b32 s38, 21504
    s_mov_b32 s39, 0x00020000
    v_lshlrev_b32 v3, 4, v1
    buffer_load_dwordx4 v[12:15], v3, s[24:27], 0 offen
    s_lshl_b32 s47, s45, 10
    s_lshl_b32 s49, s53, 4
    s_add_u32 s47, s47, s49
    v_lshlrev_b32 v24, 5, v5
    v_lshl_add_u32 v24, v6, 2, v24
    v_add_u32 v24, s47, v24
    v_lshlrev_b32 v3, 1, v24
    buffer_load_dwordx2 v[16:17], v3, s[28:31], 0 offen offset:0
    buffer_load_dwordx2 v[18:19], v3, s[28:31], 0 offen offset:16
    s_lshl_b32 s47, s46, 2
    s_add_u32 s54, s16, s47
    s_addc_u32 s55, s17, 0
    s_load_dword s56, s[54:55], 0
    s_load_dword s57, s[54:55], 1792
    s_load_dword s58, s[54:55], 3584
    s_load_dword s96, s[54:55], 10752
    s_load_dword s97, s[54:55], 12544
    s_load_dword s98, s[54:55], 14336
    v_lshlrev_b32 v67, 5, v65
    s_mov_b32 s47, 7168
    buffer_load_dwordx4 v[68:71], v67, s[36:39], s47 offen
    buffer_load_dwordx4 v[72:75], v67, s[36:39], s47 offen offset:16
    s_mov_b32 s47, 5376
    buffer_load_dwordx4 v[76:79], v67, s[36:39], s47 offen
    buffer_load_dwordx4 v[80:83], v67, s[36:39], s47 offen offset:16
    s_mov_b32 s47, 17920
    buffer_load_dwordx4 v[44:47], v67, s[36:39], s47 offen
    buffer_load_dwordx4 v[48:51], v67, s[36:39], s47 offen offset:16
    s_mov_b32 s47, 16128
    buffer_load_dwordx4 v[52:55], v67, s[36:39], s47 offen
    buffer_load_dwordx4 v[56:59], v67, s[36:39], s47 offen offset:16
    v_lshlrev_b32 v3, 3, v24
    buffer_load_dwordx4 v[28:31], v3, s[32:35], 0 offen offset:0
    buffer_load_dwordx4 v[32:35], v3, s[32:35], 0 offen offset:16
    buffer_load_dwordx4 v[36:39], v3, s[32:35], 0 offen offset:64
    buffer_load_dwordx4 v[40:43], v3, s[32:35], 0 offen offset:80
    s_waitcnt vmcnt(14)
    ds_write_b128 v88, v[12:15] offset:33280
    s_waitcnt lgkmcnt(0)
    s_barrier
    s_lshl_b32 s47, s45, 5
    s_sub_u32 s47, 63, s47
    v_sub_u32 v3, s47, v5
    v_mul_u32_u24 v173, 80, v3
    v_lshlrev_b32 v3, 3, v6
    v_sub_u32 v173, v173, v3
    s_lshl_b32 s47, s53, 5
    s_sub_u32 s47, s48, s47
    v_add_u32 v173, s47, v173
    ds_read_b64 v[174:175], v173 offset:33336
    ds_read_b64 v[176:177], v173 offset:33320
    s_getreg_b32 s64, hwreg(HW_REG_XCC_ID)
    s_and_b32 s64, s64, 7
    s_cmp_lg_u32 s3, 7
    s_cbranch_scc1 MG_NOTK0
    s_mov_b64 exec, 1
    v_mov_b32 v8, 1
    v_mov_b32 v9, 0
    s_lshl_b32 s47, s64, 7
    s_add_u32 s47, s47, 8192
    buffer_atomic_add v8, v9, s[40:43], s47 offen sc0 sc1
    s_mov_b64 exec, -1
MG_NOTK0:
    ds_read_b128 v[124:127], v90 offset:0
    ds_read_b128 v[128:131], v91 offset:33280
    ds_read_b128 v[132:135], v91 offset:35840
    ds_read_b128 v[136:139], v90 offset:2048
    ds_read_b128 v[140:143], v90 offset:64
    ds_read_b128 v[144:147], v91 offset:33360
    ds_read_b128 v[148:151], v91 offset:35920
    ds_read_b128 v[152:155], v90 offset:2112
    ds_read_b128 v[156:159], v90 offset:128
    ds_read_b128 v[160:163], v91 offset:33440
    ds_read_b128 v[164:167], v91 offset:36000
    ds_read_b128 v[168:171], v90 offset:2176
    s_waitcnt lgkmcnt(8)
    v_mfma_f32_32x32x16_bf16 v[108:123], v[124:127], v[128:131], v[108:123]
    s_add_u32 s32, s16, 8388608
    s_addc_u32 s33, s17, 0
    s_mov_b32 s34, 3211264
    s_mov_b32 s35, 0x00020000
    v_lshrrev_b32 v3, 1, v65
    v_lshlrev_b32 v172, 10, v3
    v_and_b32 v3, 7, v64
    v_mfma_f32_32x32x16_bf16 v[92:107], v[124:127], v[132:135], v[92:107]
    v_lshl_add_u32 v172, v3, 5, v172
    v_and_b32 v3, 1, v65
    v_lshl_add_u32 v172, v3, 9, v172
    v_lshrrev_b32 v3, 3, v64
    v_mul_u32_u24 v3, 28672, v3
    v_add_u32 v172, v172, v3
    v_mov_b32 v188, 0
    v_mfma_f32_32x32x16_bf16 v[108:123], v[136:139], v[132:135], v[108:123]
    v_mov_b32 v189, 0
    v_mov_b32 v190, 0
    v_mov_b32 v191, 0
    s_and_b32 s47, s3, 3
    s_lshl_b32 s49, s47, 13
    s_add_u32 s49, s49, s48
    v_lshlrev_b32 v178, 4, v2
    ds_read_b128 v[124:127], v90 offset:192
    ds_read_b128 v[128:131], v91 offset:33520
    ds_read_b128 v[132:135], v91 offset:36080
    ds_read_b128 v[136:139], v90 offset:2240
    s_waitcnt lgkmcnt(8)
    v_mfma_f32_32x32x16_bf16 v[108:123], v[140:143], v[144:147], v[108:123]
    v_add_u32 v178, s49, v178
    s_lshl_b32 s49, s47, 11
    s_add_u32 s49, s49, s48
    v_lshlrev_b32 v179, 4, v2
    v_add_u32 v179, s49, v179
    v_lshlrev_b32 v180, 6, v5
    v_lshl_add_u32 v180, v6, 3, v180
    v_mfma_f32_32x32x16_bf16 v[92:107], v[140:143], v[148:151], v[92:107]
    s_lshl_b32 s47, s45, 11
    s_lshl_b32 s49, s53, 5
    s_add_u32 s47, s47, s49
    s_lshl_b32 s49, s44, 12
    s_add_u32 s47, s47, s49
    s_add_u32 s47, s47, 90112
    v_add_u32 v180, s47, v180
    v_mfma_f32_32x32x16_bf16 v[108:123], v[152:155], v[148:151], v[108:123]
    s_waitcnt lgkmcnt(0)
    s_lshl_b32 s47, s44, 4
    s_lshr_b32 s59, s59, s47
    s_lshl_b32 s59, s59, 16
    v_mov_b32 v181, s59
    v_mov_b32 v182, s57
    v_add_f32 v182, s97, v182
    ds_read_b128 v[140:143], v90 offset:256
    ds_read_b128 v[144:147], v91 offset:33600
    ds_read_b128 v[148:151], v91 offset:36160
    ds_read_b128 v[152:155], v90 offset:2304
    s_waitcnt lgkmcnt(8)
    v_mfma_f32_32x32x16_bf16 v[108:123], v[156:159], v[160:163], v[108:123]
    v_cvt_pk_bf16_f32 v182, v182, v182
    v_lshlrev_b32 v182, 16, v182
    v_add_f32 v182, 1.0, v182
    v_cvt_pk_bf16_f32 v182, v182, v182
    v_lshlrev_b32 v182, 16, v182
    v_mov_b32 v183, s56
    v_mov_b32 v184, s58
    v_mfma_f32_32x32x16_bf16 v[92:107], v[156:159], v[164:167], v[92:107]
    v_add_f32 v183, s96, v183
    v_add_f32 v184, s98, v184
    v_cvt_pk_bf16_f32 v3, v183, v184
    v_lshlrev_b32 v183, 16, v3
    v_and_b32 v184, 0xffff0000, v3
    v_and_b32 v208, 0xffff0000, v175
    v_lshlrev_b32 v209, 16, v175
    v_mfma_f32_32x32x16_bf16 v[108:123], v[168:171], v[164:167], v[108:123]
    v_mul_f32 v208, v208, v181
    v_mul_f32 v209, v209, v181
    v_cvt_pk_bf16_f32 v4, v208, v209
    v_lshlrev_b32 v208, 16, v4
    v_and_b32 v209, 0xffff0000, v4
    v_and_b32 v210, 0xffff0000, v174
    v_lshlrev_b32 v211, 16, v174
    ds_read_b128 v[156:159], v90 offset:320
    ds_read_b128 v[160:163], v91 offset:33680
    ds_read_b128 v[164:167], v91 offset:36240
    ds_read_b128 v[168:171], v90 offset:2368
    s_waitcnt lgkmcnt(8)
    v_mfma_f32_32x32x16_bf16 v[108:123], v[124:127], v[128:131], v[108:123]
    v_mul_f32 v210, v210, v181
    v_mul_f32 v211, v211, v181
    v_cvt_pk_bf16_f32 v4, v210, v211
    v_lshlrev_b32 v210, 16, v4
    v_and_b32 v211, 0xffff0000, v4
    v_and_b32 v212, 0xffff0000, v177
    v_lshlrev_b32 v213, 16, v177
    v_mfma_f32_32x32x16_bf16 v[92:107], v[124:127], v[132:135], v[92:107]
    v_mul_f32 v212, v212, v181
    v_mul_f32 v213, v213, v181
    v_cvt_pk_bf16_f32 v4, v212, v213
    v_lshlrev_b32 v212, 16, v4
    v_and_b32 v213, 0xffff0000, v4
    v_and_b32 v214, 0xffff0000, v176
    v_lshlrev_b32 v215, 16, v176
    v_mfma_f32_32x32x16_bf16 v[108:123], v[136:139], v[132:135], v[108:123]
    v_mul_f32 v214, v214, v181
    v_mul_f32 v215, v215, v181
    v_cvt_pk_bf16_f32 v4, v214, v215
    v_lshlrev_b32 v214, 16, v4
    v_and_b32 v215, 0xffff0000, v4
    s_waitcnt vmcnt(0)
    s_mov_b32 s36, s18
    s_mov_b32 s37, s19
    s_mov_b32 s38, 1605632
    s_mov_b32 s39, 0x00020000
    v_and_b32 v254, 255, v0
    v_min_u32 v254, 223, v254
    v_lshlrev_b32 v254, 2, v254
    s_lshr_b32 s47, s2, 1
    s_lshl_b32 s47, s47, 4
    s_and_b32 s49, s2, 1
    s_lshl_b32 s49, s49, 2
    s_add_u32 s47, s47, s49
    s_mul_i32 s47, s47, 896
    s_add_u32 s49, s47, 7168
    buffer_load_dword v240, v254, s[36:39], s47 offen offset:0
    buffer_load_dword v241, v254, s[36:39], s47 offen offset:896
    buffer_load_dword v242, v254, s[36:39], s47 offen offset:1792
    buffer_load_dword v243, v254, s[36:39], s47 offen offset:2688
    buffer_load_dword v244, v254, s[36:39], s49 offen offset:0
    buffer_load_dword v245, v254, s[36:39], s49 offen offset:896
    buffer_load_dword v246, v254, s[36:39], s49 offen offset:1792
    buffer_load_dword v247, v254, s[36:39], s49 offen offset:2688
    ds_read_b128 v[124:127], v90 offset:384
    ds_read_b128 v[128:131], v91 offset:33760
    ds_read_b128 v[132:135], v91 offset:36320
    ds_read_b128 v[136:139], v90 offset:2432
    s_waitcnt lgkmcnt(8)
    v_mfma_f32_32x32x16_bf16 v[108:123], v[140:143], v[144:147], v[108:123]
    v_add_f32 v68, v68, v44
    v_add_f32 v76, v76, v52
    v_add_f32 v69, v69, v45
    v_add_f32 v77, v77, v53
    v_add_f32 v70, v70, v46
    v_add_f32 v78, v78, v54
    v_add_f32 v71, v71, v47
    v_mfma_f32_32x32x16_bf16 v[92:107], v[140:143], v[148:151], v[92:107]
    v_add_f32 v79, v79, v55
    v_add_f32 v72, v72, v48
    v_add_f32 v80, v80, v56
    v_add_f32 v73, v73, v49
    v_add_f32 v81, v81, v57
    v_add_f32 v74, v74, v50
    v_add_f32 v82, v82, v58
    v_mfma_f32_32x32x16_bf16 v[108:123], v[152:155], v[148:151], v[108:123]
    v_add_f32 v75, v75, v51
    v_add_f32 v83, v83, v59
    v_cvt_pk_bf16_f32 v3, v68, v69
    v_lshlrev_b32 v68, 16, v3
    v_and_b32 v69, 0xffff0000, v3
    v_cvt_pk_bf16_f32 v4, v76, v77
    v_lshlrev_b32 v76, 16, v4
    ds_read_b128 v[140:143], v90 offset:448
    ds_read_b128 v[144:147], v91 offset:33840
    ds_read_b128 v[148:151], v91 offset:36400
    ds_read_b128 v[152:155], v90 offset:2496
    s_waitcnt lgkmcnt(8)
    v_mfma_f32_32x32x16_bf16 v[108:123], v[156:159], v[160:163], v[108:123]
    v_and_b32 v77, 0xffff0000, v4
    v_cvt_pk_bf16_f32 v3, v70, v71
    v_lshlrev_b32 v70, 16, v3
    v_and_b32 v71, 0xffff0000, v3
    v_cvt_pk_bf16_f32 v4, v78, v79
    v_lshlrev_b32 v78, 16, v4
    v_and_b32 v79, 0xffff0000, v4
    v_mfma_f32_32x32x16_bf16 v[92:107], v[156:159], v[164:167], v[92:107]
    v_cvt_pk_bf16_f32 v3, v72, v73
    v_lshlrev_b32 v72, 16, v3
    v_and_b32 v73, 0xffff0000, v3
    v_cvt_pk_bf16_f32 v4, v80, v81
    v_lshlrev_b32 v80, 16, v4
    v_and_b32 v81, 0xffff0000, v4
    v_cvt_pk_bf16_f32 v3, v74, v75
    v_mfma_f32_32x32x16_bf16 v[108:123], v[168:171], v[164:167], v[108:123]
    v_lshlrev_b32 v74, 16, v3
    v_and_b32 v75, 0xffff0000, v3
    v_cvt_pk_bf16_f32 v4, v82, v83
    v_lshlrev_b32 v82, 16, v4
    v_and_b32 v83, 0xffff0000, v4
    v_add_f32 v68, 1.0, v68
    v_add_f32 v69, 1.0, v69
    ds_read_b128 v[156:159], v90 offset:512
    ds_read_b128 v[160:163], v91 offset:33920
    ds_read_b128 v[164:167], v91 offset:36480
    ds_read_b128 v[168:171], v90 offset:2560
    s_waitcnt lgkmcnt(8)
    v_mfma_f32_32x32x16_bf16 v[108:123], v[124:127], v[128:131], v[108:123]
    v_add_f32 v70, 1.0, v70
    v_add_f32 v71, 1.0, v71
    v_add_f32 v72, 1.0, v72
    v_add_f32 v73, 1.0, v73
    v_add_f32 v74, 1.0, v74
    v_add_f32 v75, 1.0, v75
    v_cvt_pk_bf16_f32 v3, v68, v69
    v_mfma_f32_32x32x16_bf16 v[92:107], v[124:127], v[132:135], v[92:107]
    v_lshlrev_b32 v68, 16, v3
    v_and_b32 v69, 0xffff0000, v3
    v_cvt_pk_bf16_f32 v3, v70, v71
    v_lshlrev_b32 v70, 16, v3
    v_and_b32 v71, 0xffff0000, v3
    v_cvt_pk_bf16_f32 v3, v72, v73
    v_lshlrev_b32 v72, 16, v3
    v_mfma_f32_32x32x16_bf16 v[108:123], v[136:139], v[132:135], v[108:123]
    v_and_b32 v73, 0xffff0000, v3
    v_cvt_pk_bf16_f32 v3, v74, v75
    v_lshlrev_b32 v74, 16, v3
    v_and_b32 v75, 0xffff0000, v3
    v_lshlrev_b32 v192, 16, v232
    v_and_b32 v200, 0xffff0000, v232
    v_fmac_f32 v190, v192, v76
    ds_read_b128 v[124:127], v90 offset:576
    ds_read_b128 v[128:131], v91 offset:34000
    ds_read_b128 v[132:135], v91 offset:36560
    ds_read_b128 v[136:139], v90 offset:2624
    s_waitcnt lgkmcnt(8)
    v_mfma_f32_32x32x16_bf16 v[108:123], v[140:143], v[144:147], v[108:123]
    v_fmac_f32 v191, v200, v76
    v_mul_f32 v192, v192, v68
    v_mul_f32 v200, v200, v68
    v_lshlrev_b32 v193, 16, v233
    v_and_b32 v201, 0xffff0000, v233
    v_fmac_f32 v190, v193, v77
    v_fmac_f32 v191, v201, v77
    v_mfma_f32_32x32x16_bf16 v[92:107], v[140:143], v[148:151], v[92:107]
    v_mul_f32 v193, v193, v69
    v_mul_f32 v201, v201, v69
    v_lshlrev_b32 v194, 16, v234
    v_and_b32 v202, 0xffff0000, v234
    v_fmac_f32 v190, v194, v78
    v_fmac_f32 v191, v202, v78
    v_mfma_f32_32x32x16_bf16 v[108:123], v[152:155], v[148:151], v[108:123]
    v_mul_f32 v194, v194, v70
    v_mul_f32 v202, v202, v70
    v_lshlrev_b32 v195, 16, v235
    v_and_b32 v203, 0xffff0000, v235
    v_fmac_f32 v190, v195, v79
    v_fmac_f32 v191, v203, v79
    ds_read_b128 v[140:143], v90 offset:640
    ds_read_b128 v[144:147], v91 offset:34080
    ds_read_b128 v[148:151], v91 offset:36640
    ds_read_b128 v[152:155], v90 offset:2688
    s_waitcnt lgkmcnt(8)
    v_mfma_f32_32x32x16_bf16 v[108:123], v[156:159], v[160:163], v[108:123]
    v_mul_f32 v195, v195, v71
    v_mul_f32 v203, v203, v71
    v_lshlrev_b32 v196, 16, v236
    v_and_b32 v204, 0xffff0000, v236
    v_fmac_f32 v190, v196, v80
    v_fmac_f32 v191, v204, v80
    v_mfma_f32_32x32x16_bf16 v[92:107], v[156:159], v[164:167], v[92:107]
    v_mul_f32 v196, v196, v72
    v_mul_f32 v204, v204, v72
    v_lshlrev_b32 v197, 16, v237
    v_and_b32 v205, 0xffff0000, v237
    v_fmac_f32 v190, v197, v81
    v_fmac_f32 v191, v205, v81
    v_mfma_f32_32x32x16_bf16 v[108:123], v[168:171], v[164:167], v[108:123]
    v_mul_f32 v197, v197, v73
    v_mul_f32 v205, v205, v73
    v_lshlrev_b32 v198, 16, v238
    v_and_b32 v206, 0xffff0000, v238
    v_fmac_f32 v190, v198, v82
    v_fmac_f32 v191, v206, v82
    ds_read_b128 v[156:159], v90 offset:704
    ds_read_b128 v[160:163], v91 offset:34160
    ds_read_b128 v[164:167], v91 offset:36720
    ds_read_b128 v[168:171], v90 offset:2752
    s_waitcnt lgkmcnt(8)
    v_mfma_f32_32x32x16_bf16 v[108:123], v[124:127], v[128:131], v[108:123]
    v_mul_f32 v198, v198, v74
    v_mul_f32 v206, v206, v74
    v_lshlrev_b32 v199, 16, v239
    v_and_b32 v207, 0xffff0000, v239
    v_fmac_f32 v190, v199, v83
    v_fmac_f32 v191, v207, v83
    v_mfma_f32_32x32x16_bf16 v[92:107], v[124:127], v[132:135], v[92:107]
    v_mul_f32 v199, v199, v75
    v_mul_f32 v207, v207, v75
    v_cvt_pk_bf16_f32 v224, v192, v193
    v_cvt_pk_bf16_f32 v228, v200, v201
    v_cvt_pk_bf16_f32 v225, v194, v195
    v_cvt_pk_bf16_f32 v229, v202, v203
    v_mfma_f32_32x32x16_bf16 v[108:123], v[136:139], v[132:135], v[108:123]
    v_cvt_pk_bf16_f32 v226, v196, v197
    v_cvt_pk_bf16_f32 v230, v204, v205
    v_cvt_pk_bf16_f32 v227, v198, v199
    v_cvt_pk_bf16_f32 v231, v206, v207
    v_dot2_f32_bf16 v188, v224, s50, v188
    v_dot2_f32_bf16 v189, v228, s50, v189
    ds_read_b128 v[124:127], v90 offset:768
    ds_read_b128 v[128:131], v91 offset:34240
    ds_read_b128 v[132:135], v91 offset:36800
    ds_read_b128 v[136:139], v90 offset:2816
    s_waitcnt lgkmcnt(8)
    v_mfma_f32_32x32x16_bf16 v[108:123], v[140:143], v[144:147], v[108:123]
    v_dot2_f32_bf16 v188, v225, s50, v188
    v_dot2_f32_bf16 v189, v229, s50, v189
    v_dot2_f32_bf16 v188, v226, s50, v188
    v_dot2_f32_bf16 v189, v230, s50, v189
    v_dot2_f32_bf16 v188, v227, s50, v188
    v_dot2_f32_bf16 v189, v231, s50, v189
    v_mfma_f32_32x32x16_bf16 v[92:107], v[140:143], v[148:151], v[92:107]
    v_mov_b32 v4, v172
    v_add_u32 v3, 16, v172
    v_permlane32_swap_b32 v224, v228
    v_permlane32_swap_b32 v225, v229
    v_permlane32_swap_b32 v226, v230
    v_permlane32_swap_b32 v227, v231
    v_mfma_f32_32x32x16_bf16 v[108:123], v[152:155], v[148:151], v[108:123]
    v_permlane32_swap_b32 v4, v3
    s_mul_i32 s47, s61, 114688
    s_lshl_b32 s49, s60, 8
    s_add_u32 s47, s47, s49
    v_lshlrev_b32 v172, 4, v0
    v_add_u32 v172, 81920, v172
    ds_read_b128 v[140:143], v90 offset:832
    ds_read_b128 v[144:147], v91 offset:34320
    ds_read_b128 v[148:151], v91 offset:36880
    ds_read_b128 v[152:155], v90 offset:2880
    s_waitcnt lgkmcnt(8)
    v_mfma_f32_32x32x16_bf16 v[108:123], v[156:159], v[160:163], v[108:123]
    s_cmp_eq_u32 s3, 7
    s_cbranch_scc1 MG_W7B
    buffer_store_dwordx4 v[224:227], v4, s[32:35], s47 offen sc1
    buffer_store_dwordx4 v[228:231], v3, s[32:35], s47 offen sc1
    ds_write_b128 v172, v[188:191]
MG_W7B:
    v_lshlrev_b32 v216, 16, v16
    v_and_b32 v217, 0xffff0000, v16
    v_sub_f32 v216, v216, v28
    v_sub_f32 v217, v217, v30
    v_mfma_f32_32x32x16_bf16 v[92:107], v[156:159], v[164:167], v[92:107]
    v_cvt_pk_bf16_f32 v4, v216, v217
    v_lshlrev_b32 v216, 16, v4
    v_and_b32 v217, 0xffff0000, v4
    v_mul_f32 v216, v216, v29
    v_mul_f32 v217, v217, v31
    v_cvt_pk_bf16_f32 v4, v216, v217
    v_mfma_f32_32x32x16_bf16 v[108:123], v[168:171], v[164:167], v[108:123]
    v_lshlrev_b32 v216, 16, v4
    v_and_b32 v217, 0xffff0000, v4
    v_mul_f32 v216, v216, v182
    v_mul_f32 v217, v217, v182
    v_cvt_pk_bf16_f32 v4, v216, v217
    v_lshlrev_b32 v216, 16, v4
    ds_read_b128 v[156:159], v90 offset:896
    ds_read_b128 v[160:163], v91 offset:34400
    ds_read_b128 v[164:167], v91 offset:36960
    ds_read_b128 v[168:171], v90 offset:2944
    s_waitcnt lgkmcnt(8)
    v_mfma_f32_32x32x16_bf16 v[108:123], v[124:127], v[128:131], v[108:123]
    v_and_b32 v217, 0xffff0000, v4
    v_add_f32 v216, v216, v183
    v_add_f32 v217, v217, v183
    v_cvt_pk_bf16_f32 v4, v216, v217
    v_lshlrev_b32 v28, 16, v4
    v_and_b32 v30, 0xffff0000, v4
    v_mfma_f32_32x32x16_bf16 v[92:107], v[124:127], v[132:135], v[92:107]
    v_lshlrev_b32 v216, 16, v17
    v_and_b32 v217, 0xffff0000, v17
    v_sub_f32 v216, v216, v32
    v_sub_f32 v217, v217, v34
    v_cvt_pk_bf16_f32 v4, v216, v217
    v_lshlrev_b32 v216, 16, v4
    v_mfma_f32_32x32x16_bf16 v[108:123], v[136:139], v[132:135], v[108:123]
    v_and_b32 v217, 0xffff0000, v4
    v_mul_f32 v216, v216, v33
    v_mul_f32 v217, v217, v35
    v_cvt_pk_bf16_f32 v4, v216, v217
    v_lshlrev_b32 v216, 16, v4
    v_and_b32 v217, 0xffff0000, v4
    ds_read_b128 v[124:127], v90 offset:960
    ds_read_b128 v[128:131], v91 offset:34480
    ds_read_b128 v[132:135], v91 offset:37040
    ds_read_b128 v[136:139], v90 offset:3008
    s_waitcnt lgkmcnt(8)
    v_mfma_f32_32x32x16_bf16 v[108:123], v[140:143], v[144:147], v[108:123]
    v_mul_f32 v216, v216, v182
    v_mul_f32 v217, v217, v182
    v_cvt_pk_bf16_f32 v4, v216, v217
    v_lshlrev_b32 v216, 16, v4
    v_and_b32 v217, 0xffff0000, v4
    v_add_f32 v216, v216, v183
    v_mfma_f32_32x32x16_bf16 v[92:107], v[140:143], v[148:151], v[92:107]
    v_add_f32 v217, v217, v183
    v_cvt_pk_bf16_f32 v4, v216, v217
    v_lshlrev_b32 v32, 16, v4
    v_and_b32 v34, 0xffff0000, v4
    v_lshlrev_b32 v216, 16, v18
    v_and_b32 v217, 0xffff0000, v18
    v_mfma_f32_32x32x16_bf16 v[108:123], v[152:155], v[148:151], v[108:123]
    v_sub_f32 v216, v216, v36
    v_sub_f32 v217, v217, v38
    v_cvt_pk_bf16_f32 v4, v216, v217
    v_lshlrev_b32 v216, 16, v4
    v_and_b32 v217, 0xffff0000, v4
    v_mul_f32 v216, v216, v37
    s_waitcnt lgkmcnt(4)
    v_mfma_f32_32x32x16_bf16 v[108:123], v[156:159], v[160:163], v[108:123]
    v_mul_f32 v217, v217, v39
    v_cvt_pk_bf16_f32 v4, v216, v217
    v_lshlrev_b32 v216, 16, v4
    v_and_b32 v217, 0xffff0000, v4
    v_mul_f32 v216, v216, v182
    v_mul_f32 v217, v217, v182
    v_mfma_f32_32x32x16_bf16 v[92:107], v[156:159], v[164:167], v[92:107]
    v_cvt_pk_bf16_f32 v4, v216, v217
    v_lshlrev_b32 v216, 16, v4
    v_and_b32 v217, 0xffff0000, v4
    v_add_f32 v216, v216, v183
    v_add_f32 v217, v217, v183
    v_cvt_pk_bf16_f32 v4, v216, v217
    v_mfma_f32_32x32x16_bf16 v[108:123], v[168:171], v[164:167], v[108:123]
    v_lshlrev_b32 v36, 16, v4
    v_and_b32 v38, 0xffff0000, v4
    v_lshlrev_b32 v216, 16, v19
    v_and_b32 v217, 0xffff0000, v19
    v_sub_f32 v216, v216, v40
    v_sub_f32 v217, v217, v42
    s_waitcnt lgkmcnt(0)
    v_mfma_f32_32x32x16_bf16 v[108:123], v[124:127], v[128:131], v[108:123]
    v_cvt_pk_bf16_f32 v4, v216, v217
    v_lshlrev_b32 v216, 16, v4
    v_and_b32 v217, 0xffff0000, v4
    v_mul_f32 v216, v216, v41
    v_mul_f32 v217, v217, v43
    v_cvt_pk_bf16_f32 v4, v216, v217
    v_mfma_f32_32x32x16_bf16 v[92:107], v[124:127], v[132:135], v[92:107]
    v_lshlrev_b32 v216, 16, v4
    v_and_b32 v217, 0xffff0000, v4
    v_mul_f32 v216, v216, v182
    v_mul_f32 v217, v217, v182
    v_cvt_pk_bf16_f32 v4, v216, v217
    v_lshlrev_b32 v216, 16, v4
    v_mfma_f32_32x32x16_bf16 v[108:123], v[136:139], v[132:135], v[108:123]
    v_and_b32 v217, 0xffff0000, v4
    v_add_f32 v216, v216, v183
    v_add_f32 v217, v217, v183
    v_cvt_pk_bf16_f32 v4, v216, v217
    v_lshlrev_b32 v40, 16, v4
    v_and_b32 v42, 0xffff0000, v4
    s_cmp_lg_u32 s3, 7
    s_cbranch_scc1 MG_NOTK
    s_mov_b32 s65, 0
    s_mov_b64 exec, 1
MG_TKL:
    s_waitcnt vmcnt(0)
    v_readfirstlane_b32 s47, v8
    s_nop 0
    s_cmp_lt_u32 s47, 28
    s_cbranch_scc1 MG_TKOK
    s_add_u32 s64, s64, 1
    s_and_b32 s64, s64, 7
    s_add_u32 s65, s65, 1
    s_mov_b32 s47, 0
    s_cmp_ge_u32 s65, 8
    s_cbranch_scc1 MG_TKOK
    v_mov_b32 v8, 1
    s_lshl_b32 s47, s64, 7
    s_add_u32 s47, s47, 8192
    buffer_atomic_add v8, v9, s[40:43], s47 offen sc0 sc1
    s_branch MG_TKL
MG_TKOK:
    s_lshl_b32 s47, s47, 3
    s_add_u32 s47, s47, s64
    v_mov_b32 v8, s47
    v_mov_b32 v9, 131072
    ds_write_b32 v9, v8
    s_mov_b64 exec, -1
MG_NOTK:
    s_waitcnt lgkmcnt(0)
    s_barrier
    s_nop 7
    ds_write_b128 v178, v[92:95] offset:0
    ds_write_b128 v178, v[96:99] offset:1024
    ds_write_b128 v178, v[100:103] offset:2048
    ds_write_b128 v178, v[104:107] offset:3072
    ds_write_b128 v178, v[108:111] offset:4096
    ds_write_b128 v178, v[112:115] offset:5120
    ds_write_b128 v178, v[116:119] offset:6144
    ds_write_b128 v178, v[120:123] offset:7168
    s_lshr_b32 s47, s61, 1
    s_lshl_b32 s47, s47, 7
    s_add_u32 s47, s47, 6144
    s_waitcnt vmcnt(0) lgkmcnt(0)
    s_barrier
    s_cmp_lg_u32 s3, 0
    s_cbranch_scc1 SIG_SP
    s_mov_b64 exec, 1
    v_mov_b32 v8, 1
    v_mov_b32 v9, 0
    buffer_atomic_add v8, v9, s[40:43], s47 offen sc1
    s_mov_b64 exec, -1
SIG_SP:
    s_add_u32 s32, s16, 36864
    s_addc_u32 s33, s17, 0
    s_mov_b32 s34, 28672
    s_mov_b32 s35, 0x00020000
    s_cmp_lt_u32 s3, 6
    s_cbranch_scc1 MG_NOCS
    v_and_b32 v24, 127, v0
    v_lshlrev_b32 v3, 2, v24
    v_add_u32 v3, 81920, v3
    ds_read_b32 v156, v3 offset:0
    ds_read_b32 v157, v3 offset:512
    ds_read_b32 v158, v3 offset:1024
    ds_read_b32 v159, v3 offset:1536
    ds_read_b32 v160, v3 offset:2048
    ds_read_b32 v161, v3 offset:2560
    ds_read_b32 v162, v3 offset:3072
    ds_read_b32 v163, v3 offset:3584
    ds_read_b32 v164, v3 offset:4096
    ds_read_b32 v165, v3 offset:4608
    ds_read_b32 v166, v3 offset:5120
    ds_read_b32 v167, v3 offset:5632
    ds_read_b32 v168, v3 offset:6144
    ds_read_b32 v169, v3 offset:6656
    v_lshrrev_b32 v66, 2, v24
    v_lshlrev_b32 v66, 1, v66
    v_and_b32 v4, 1, v24
    v_add_u32 v66, v66, v4
    v_lshrrev_b32 v3, 4, v66
    v_lshlrev_b32 v3, 1, v3
    v_bfe_u32 v4, v66, 2, 1
    v_add_u32 v3, v3, v4
    v_lshlrev_b32 v3, 2, v3
    v_bfe_u32 v4, v24, 1, 1
    v_add_u32 v3, v3, v4
    v_lshlrev_b32 v3, 3, v3
    v_bfe_u32 v4, v66, 3, 1
    v_lshl_add_u32 v3, v4, 2, v3
    v_and_b32 v4, 3, v66
    v_add_lshl_u32 v3, v3, v4, 2
    s_lshl_b32 s47, s61, 10
    s_lshl_b32 s49, s60, 6
    s_add_u32 s47, s47, s49
    s_waitcnt lgkmcnt(0)
    v_add_f32 v156, v156, v163
    v_add_f32 v157, v157, v164
    v_add_f32 v158, v158, v165
    v_add_f32 v159, v159, v166
    v_add_f32 v160, v160, v167
    v_add_f32 v161, v161, v168
    v_add_f32 v162, v162, v169
    v_add_f32 v156, v156, v157
    v_add_f32 v156, v156, v158
    v_add_f32 v156, v156, v159
    v_add_f32 v156, v156, v160
    v_add_f32 v156, v156, v161
    v_add_f32 v156, v156, v162
    buffer_atomic_add_f32 v156, v3, s[32:35], s47 offen sc1
MG_NOCS:
    v_min_u32 v254, 223, v0
    v_lshrrev_b32 v255, 4, v254
    v_mul_u32_u24 v255, 114688, v255
    v_and_b32 v254, 15, v254
    v_lshl_add_u32 v254, v254, 5, v255
    v_add_u32 v255, 16, v254
    s_nop 1
    v_permlane32_swap_b32 v254, v255
    v_perm_b32 v224, v241, v240, s51
    v_perm_b32 v228, v241, v240, s52
    v_perm_b32 v225, v243, v242, s51
    v_perm_b32 v229, v243, v242, s52
    v_perm_b32 v226, v245, v244, s51
    v_perm_b32 v230, v245, v244, s52
    v_perm_b32 v227, v247, v246, s51
    v_perm_b32 v231, v247, v246, s52
    v_permlane32_swap_b32 v224, v228
    v_permlane32_swap_b32 v225, v229
    v_permlane32_swap_b32 v226, v230
    v_permlane32_swap_b32 v227, v231
    s_add_u32 s36, s16, 13631488
    s_addc_u32 s37, s17, 0
    s_mov_b32 s38, 1605632
    s_mov_b32 s39, 0x00020000
    s_lshl_b32 s47, s2, 9
    s_cmp_ge_u32 s3, 4
    s_cbranch_scc1 WDF_SKIP
    buffer_store_dwordx4 v[224:227], v254, s[36:39], s47 offen sc1
    buffer_store_dwordx4 v[228:231], v255, s[36:39], s47 offen sc1
WDF_SKIP:
    ds_read_b128 v[124:127], v179 offset:0
    ds_read_b128 v[128:131], v179 offset:1024
    ds_read_b128 v[132:135], v179 offset:8192
    ds_read_b128 v[136:139], v179 offset:9216
    ds_read_b128 v[140:143], v179 offset:16384
    ds_read_b128 v[144:147], v179 offset:17408
    ds_read_b128 v[148:151], v179 offset:24576
    ds_read_b128 v[152:155], v179 offset:25600
    s_waitcnt lgkmcnt(0)
    v_add_f32 v192, v124, v132
    v_add_f32 v193, v125, v133
    v_add_f32 v194, v140, v148
    v_add_f32 v195, v141, v149
    v_add_f32 v192, v192, v194
    v_add_f32 v193, v193, v195
    v_cvt_pk_bf16_f32 v3, v192, v193
    v_lshlrev_b32 v192, 16, v3
    v_and_b32 v193, 0xffff0000, v3
    v_add_f32 v192, v192, v208
    v_add_f32 v193, v193, v209
    v_cvt_pk_bf16_f32 v3, v192, v193
    v_lshlrev_b32 v192, 16, v3
    v_and_b32 v193, 0xffff0000, v3
    v_mul_f32 v216, v28, v192
    v_mul_f32 v217, v30, v193
    v_cvt_pk_bf16_f32 v4, v216, v217
    v_lshlrev_b32 v216, 16, v4
    v_and_b32 v217, 0xffff0000, v4
    v_mul_f32 v216, v216, v184
    v_mul_f32 v217, v217, v184
    v_cvt_pk_bf16_f32 v4, v216, v217
    v_lshlrev_b32 v216, 16, v4
    v_and_b32 v217, 0xffff0000, v4
    v_lshlrev_b32 v196, 16, v16
    v_and_b32 v197, 0xffff0000, v16
    v_add_f32 v196, v196, v216
    v_add_f32 v197, v197, v217
    v_cvt_pk_bf16_f32 v200, v196, v197
    v_add_f32 v192, v126, v134
    v_add_f32 v193, v127, v135
    v_add_f32 v194, v142, v150
    v_add_f32 v195, v143, v151
    v_add_f32 v192, v192, v194
    v_add_f32 v193, v193, v195
    v_cvt_pk_bf16_f32 v3, v192, v193
    v_lshlrev_b32 v192, 16, v3
    v_and_b32 v193, 0xffff0000, v3
    v_add_f32 v192, v192, v210
    v_add_f32 v193, v193, v211
    v_cvt_pk_bf16_f32 v3, v192, v193
    v_lshlrev_b32 v192, 16, v3
    v_and_b32 v193, 0xffff0000, v3
    v_mul_f32 v216, v32, v192
    v_mul_f32 v217, v34, v193
    v_cvt_pk_bf16_f32 v4, v216, v217
    v_lshlrev_b32 v216, 16, v4
    v_and_b32 v217, 0xffff0000, v4
    v_mul_f32 v216, v216, v184
    v_mul_f32 v217, v217, v184
    v_cvt_pk_bf16_f32 v4, v216, v217
    v_lshlrev_b32 v216, 16, v4
    v_and_b32 v217, 0xffff0000, v4
    v_lshlrev_b32 v196, 16, v17
    v_and_b32 v197, 0xffff0000, v17
    v_add_f32 v196, v196, v216
    v_add_f32 v197, v197, v217
    v_cvt_pk_bf16_f32 v201, v196, v197
    ds_write_b64 v180, v[200:201] offset:0
    v_add_f32 v192, v128, v136
    v_add_f32 v193, v129, v137
    v_add_f32 v194, v144, v152
    v_add_f32 v195, v145, v153
    v_add_f32 v192, v192, v194
    v_add_f32 v193, v193, v195
    v_cvt_pk_bf16_f32 v3, v192, v193
    v_lshlrev_b32 v192, 16, v3
    v_and_b32 v193, 0xffff0000, v3
    v_add_f32 v192, v192, v212
    v_add_f32 v193, v193, v213
    v_cvt_pk_bf16_f32 v3, v192, v193
    v_lshlrev_b32 v192, 16, v3
    v_and_b32 v193, 0xffff0000, v3
    v_mul_f32 v216, v36, v192
    v_mul_f32 v217, v38, v193
    v_cvt_pk_bf16_f32 v4, v216, v217
    v_lshlrev_b32 v216, 16, v4
    v_and_b32 v217, 0xffff0000, v4
    v_mul_f32 v216, v216, v184
    v_mul_f32 v217, v217, v184
    v_cvt_pk_bf16_f32 v4, v216, v217
    v_lshlrev_b32 v216, 16, v4
    v_and_b32 v217, 0xffff0000, v4
    v_lshlrev_b32 v196, 16, v18
    v_and_b32 v197, 0xffff0000, v18
    v_add_f32 v196, v196, v216
    v_add_f32 v197, v197, v217
    v_cvt_pk_bf16_f32 v202, v196, v197
    v_add_f32 v192, v130, v138
    v_add_f32 v193, v131, v139
    v_add_f32 v194, v146, v154
    v_add_f32 v195, v147, v155
    v_add_f32 v192, v192, v194
    v_add_f32 v193, v193, v195
    v_cvt_pk_bf16_f32 v3, v192, v193
    v_lshlrev_b32 v192, 16, v3
    v_and_b32 v193, 0xffff0000, v3
    v_add_f32 v192, v192, v214
    v_add_f32 v193, v193, v215
    v_cvt_pk_bf16_f32 v3, v192, v193
    v_lshlrev_b32 v192, 16, v3
    v_and_b32 v193, 0xffff0000, v3
    v_mul_f32 v216, v40, v192
    v_mul_f32 v217, v42, v193
    v_cvt_pk_bf16_f32 v4, v216, v217
    v_lshlrev_b32 v216, 16, v4
    v_and_b32 v217, 0xffff0000, v4
    v_mul_f32 v216, v216, v184
    v_mul_f32 v217, v217, v184
    v_cvt_pk_bf16_f32 v4, v216, v217
    v_lshlrev_b32 v216, 16, v4
    v_and_b32 v217, 0xffff0000, v4
    v_lshlrev_b32 v196, 16, v19
    v_and_b32 v197, 0xffff0000, v19
    v_add_f32 v196, v196, v216
    v_add_f32 v197, v197, v217
    v_cvt_pk_bf16_f32 v203, v196, v197
    ds_write_b64 v180, v[202:203] offset:16
    s_waitcnt lgkmcnt(0)
    s_barrier
    s_add_u32 s20, s16, 6291456
    s_addc_u32 s21, s17, 0
    s_mov_b32 s22, 1835008
    s_mov_b32 s23, 0x00020000
    v_lshrrev_b32 v3, 5, v0
    v_bfe_u32 v4, v0, 4, 1
    v_and_b32 v180, 15, v0
    v_lshlrev_b32 v180, 4, v180
    v_lshl_add_u32 v24, v3, 8, v180
    v_lshl_add_u32 v24, v4, 12, v24
    v_add_u32 v24, 90112, v24
    ds_read_b128 v[124:127], v24
    v_mul_u32_u24 v3, 114688, v3
    v_lshl_add_u32 v3, v4, 8, v3
    v_add_u32 v3, v3, v180
    s_lshl_b32 s47, s2, 9
    s_waitcnt lgkmcnt(0)
    buffer_store_dwordx4 v[124:127], v3, s[20:23], s47 offen sc1
    s_waitcnt vmcnt(0) lgkmcnt(0)
    s_barrier
    s_cmp_lg_u32 s3, 0
    s_cbranch_scc1 SIG_F2
    s_mov_b64 exec, 1
    v_mov_b32 v8, 1
    v_mov_b32 v9, 0
    s_lshl_b32 s47, s2, 2
    buffer_store_dword v8, v9, s[40:43], s47 offen sc1
    s_mov_b64 exec, -1
SIG_F2:
    s_getpc_b64 s[66:67]
Lpf2196:
    s_getreg_b32 s68, hwreg(HW_REG_HW_ID, 8, 4)
    s_and_b32 s68, s68, 7
    s_mul_i32 s68, s68, 2048
    v_lshlrev_b32 v100, 7, v0
    v_add_u32 v100, s68, v100
    v_min_u32 v100, CODE_END-Lpf2196-4, v100
    v_cmp_gt_u32 vcc, 16, v0
    s_nop 0
    s_and_saveexec_b64 s[68:69], vcc
    global_load_dword v101, v100, s[66:67]
    s_mov_b64 exec, s[68:69]
    v_mov_b32 v1, 131072
    ds_read_b32 v1, v1
    s_waitcnt lgkmcnt(0)
    v_readfirstlane_b32 s69, v1
    s_nop 0
    s_and_b32 s44, s69, 7
    s_lshr_b32 s45, s69, 3
    s_lshr_b32 s46, s44, 1
    s_lshl_b32 s46, s46, 2
    s_and_b32 s47, s45, 3
    s_add_u32 s46, s46, s47
    s_and_b32 s47, s44, 1
    s_mul_i32 s47, s47, 7
    s_lshr_b32 s48, s45, 2
    s_add_u32 s47, s47, s48
    s_lshl_b32 s47, s47, 3
    s_add_u32 s47, s47, s3
    s_add_u32 s24, s16, 8388608
    s_addc_u32 s25, s17, 0
    s_mov_b32 s26, 3211264
    s_mov_b32 s27, 0x00020000
    s_add_u32 s28, s16, 36864
    s_addc_u32 s29, s17, 0
    s_mov_b32 s30, 28672
    s_mov_b32 s31, 0x00020000
    s_add_u32 s32, s16, 16777216
    s_addc_u32 s33, s17, 0
    s_mov_b32 s34, 7340032
    s_mov_b32 s35, 0x00020000
    v_and_b32 v1, 63, v0
    v_lshrrev_b32 v6, 5, v1
    v_and_b32 v7, 31, v1
    v_lshrrev_b32 v2, 4, v1
    v_lshlrev_b32 v3, 2, v2
    v_and_b32 v4, 15, v1
    v_xor_b32 v4, v4, v3
    v_lshlrev_b32 v4, 4, v4
    v_lshl_add_u32 v4, v2, 8, v4
    s_mul_i32 s48, s46, 114688
    v_add_u32 v4, s48, v4
    v_lshlrev_b32 v5, 4, v1
    v_bfe_u32 v2, v7, 2, 1
    v_lshlrev_b32 v124, 7, v2
    v_lshrrev_b32 v2, 4, v7
    v_lshl_add_u32 v124, v2, 6, v124
    v_bfe_u32 v2, v7, 3, 1
    v_lshl_add_u32 v124, v2, 4, v124
    v_and_b32 v2, 3, v7
    v_lshl_add_u32 v124, v2, 2, v124
    s_lshl_b32 s55, s47, 8
    v_bfe_u32 v144, v1, 2, 2
    v_lshl_add_u32 v145, v6, 3, v144
    v_lshlrev_b32 v145, 8, v145
    v_bfe_u32 v2, v1, 4, 1
    v_lshl_add_u32 v145, v2, 5, v145
    v_and_b32 v2, 3, v1
    v_lshl_add_u32 v145, v2, 3, v145
    s_lshr_b32 s58, s3, 2
    s_lshl_b32 s59, s58, 12
    s_add_u32 s48, s3, 0
    s_and_b32 s48, s48, 3
    v_xor_b32 v2, s48, v144
    v_lshl_add_u32 v2, v2, 6, v145
    v_add_u32 v128, s59, v2
    v_add_u32 v136, 4096, v2
    v_subrev_u32 v136, s59, v136
    v_add_u32 v132, 0x10000, v128
    v_add_u32 v140, 0x10000, v136
    s_add_u32 s48, s3, 1
    s_and_b32 s48, s48, 3
    v_xor_b32 v2, s48, v144
    v_lshl_add_u32 v2, v2, 6, v145
    v_add_u32 v129, s59, v2
    v_add_u32 v137, 4096, v2
    v_subrev_u32 v137, s59, v137
    v_add_u32 v133, 0x10000, v129
    v_add_u32 v141, 0x10000, v137
    s_add_u32 s48, s3, 2
    s_and_b32 s48, s48, 3
    v_xor_b32 v2, s48, v144
    v_lshl_add_u32 v2, v2, 6, v145
    v_add_u32 v130, s59, v2
    v_add_u32 v138, 4096, v2
    v_subrev_u32 v138, s59, v138
    v_add_u32 v134, 0x10000, v130
    v_add_u32 v142, 0x10000, v138
    s_add_u32 s48, s3, 3
    s_and_b32 s48, s48, 3
    v_xor_b32 v2, s48, v144
    v_lshl_add_u32 v2, v2, 6, v145
    v_add_u32 v131, s59, v2
    v_add_u32 v139, 4096, v2
    v_subrev_u32 v139, s59, v139
    v_add_u32 v135, 0x10000, v131
    v_add_u32 v143, 0x10000, v139
    v_mov_b32 v148, 0
    v_mov_b32 v149, 0
    v_mov_b32 v150, 0
    v_mov_b32 v151, 0
    v_mov_b32 v152, 0
    v_mov_b32 v153, 0
    v_mov_b32 v154, 0
    v_mov_b32 v155, 0
    v_mov_b32 v156, 0
    v_mov_b32 v157, 0
    v_mov_b32 v158, 0
    v_mov_b32 v159, 0
    v_mov_b32 v160, 0
    v_mov_b32 v161, 0
    v_mov_b32 v162, 0
    v_mov_b32 v163, 0
    v_mov_b32 v164, 0
    v_mov_b32 v165, 0
    v_mov_b32 v166, 0
    v_mov_b32 v167, 0
    v_mov_b32 v168, 0
    v_mov_b32 v169, 0
    v_mov_b32 v170, 0
    v_mov_b32 v171, 0
    v_mov_b32 v172, 0
    v_mov_b32 v173, 0
    v_mov_b32 v174, 0
    v_mov_b32 v175, 0
    v_mov_b32 v176, 0
    v_mov_b32 v177, 0
    v_mov_b32 v178, 0
    v_mov_b32 v179, 0
    v_mov_b32 v180, 0
    v_mov_b32 v181, 0
    v_mov_b32 v182, 0
    v_mov_b32 v183, 0
    v_mov_b32 v184, 0
    v_mov_b32 v185, 0
    v_mov_b32 v186, 0
    v_mov_b32 v187, 0
    v_mov_b32 v188, 0
    v_mov_b32 v189, 0
    v_mov_b32 v190, 0
    v_mov_b32 v191, 0
    v_mov_b32 v192, 0
    v_mov_b32 v193, 0
    v_mov_b32 v194, 0
    v_mov_b32 v195, 0
    v_mov_b32 v196, 0
    v_mov_b32 v197, 0
    v_mov_b32 v198, 0
    v_mov_b32 v199, 0
    v_mov_b32 v200, 0
    v_mov_b32 v201, 0
    v_mov_b32 v202, 0
    v_mov_b32 v203, 0
    v_mov_b32 v204, 0
    v_mov_b32 v205, 0
    v_mov_b32 v206, 0
    v_mov_b32 v207, 0
    v_mov_b32 v208, 0
    v_mov_b32 v209, 0
    v_mov_b32 v210, 0
    v_mov_b32 v211, 0
    v_mov_b32 v244, 0
    v_mov_b32 v245, 0
    v_mov_b32 v246, 0
    v_mov_b32 v247, 0
    s_mul_i32 s54, s47, 28672
    s_lshl_b32 s56, s58, 10
    s_add_u32 s60, s54, s56
    s_sub_u32 s61, s54, s56
    s_lshl_b32 s52, s3, 10
    s_lshr_b32 s45, s47, 3
    s_lshl_b32 s45, s45, 7
    s_add_u32 s45, s45, 6144
    s_cmp_lg_u32 s3, 0
    s_cbranch_scc1 WDONE_WP
    s_mov_b64 exec, 1
    v_lshlrev_b32 v9, 7, v0
    s_mov_b32 s65, 0
WLOOP_WP:
    buffer_load_dword v8, v9, s[40:43], s45 offen sc1
    s_add_u32 s65, s65, 1
    s_waitcnt vmcnt(0)
    v_cmp_gt_u32 vcc, 16, v8
    s_cmp_ge_u32 s65, 0x40000
    s_cbranch_scc1 WOUT_WP
    s_cbranch_vccz WOUT_WP
    s_sleep 4
    s_branch WLOOP_WP
WOUT_WP:
    s_mov_b64 exec, -1
WDONE_WP:
    s_barrier
    buffer_load_dwordx4 v[12:15], v5, s[24:27], s60 offen offset:0
    buffer_load_dwordx4 v[16:19], v5, s[24:27], s61 offen offset:1024
    buffer_load_dwordx4 v[20:23], v5, s[24:27], s60 offen offset:2048
    buffer_load_dwordx4 v[24:27], v5, s[24:27], s61 offen offset:3072
    s_add_u32 s60, s60, 4096
    s_add_u32 s61, s61, 4096
    buffer_load_dwordx4 v[28:31], v5, s[24:27], s60 offen offset:0
    buffer_load_dwordx4 v[32:35], v5, s[24:27], s61 offen offset:1024
    buffer_load_dwordx4 v[36:39], v5, s[24:27], s60 offen offset:2048
    buffer_load_dwordx4 v[40:43], v5, s[24:27], s61 offen offset:3072
    s_add_u32 s60, s60, 4096
    s_add_u32 s61, s61, 4096
    buffer_load_dwordx4 v[44:47], v5, s[24:27], s60 offen offset:0
    buffer_load_dwordx4 v[48:51], v5, s[24:27], s61 offen offset:1024
    buffer_load_dwordx4 v[52:55], v5, s[24:27], s60 offen offset:2048
    buffer_load_dwordx4 v[56:59], v5, s[24:27], s61 offen offset:3072
    s_add_u32 s60, s60, 4096
    s_add_u32 s61, s61, 4096
    s_and_b32 s45, s2, 15
    s_lshl_b32 s45, s45, 7
    s_add_u32 s45, s45, 4096
    s_cmp_lg_u32 s3, 0
    s_cbranch_scc1 WF2_D
    s_mov_b32 exec_lo, -1
    s_mov_b32 exec_hi, 0x00ffffff
    v_lshlrev_b32 v9, 4, v0
    s_mov_b32 s65, 0
WF2_L:
    buffer_load_dwordx4 v[212:215], v9, s[40:43], 0 offen sc1
    s_add_u32 s65, s65, 1
    s_waitcnt vmcnt(0)
    v_and_b32 v212, v212, v213
    v_and_b32 v214, v214, v215
    v_and_b32 v212, v212, v214
    v_cmp_ne_u32 vcc, 1, v212
    s_cmp_ge_u32 s65, 0x40000
    s_cbranch_scc1 WF2_O
    s_cbranch_vccz WF2_O
    s_sleep 4
    s_branch WF2_L
WF2_O:
    s_mov_b64 exec, -1
WF2_D:
    s_barrier
    s_mov_b32 m0, s52
    s_nop 0
    buffer_load_dwordx4 v4, s[20:23], s52 offen lds
    s_add_u32 s52, s52, 8192
    s_mov_b32 m0, s52
    s_nop 0
    buffer_load_dwordx4 v4, s[20:23], s52 offen lds
    s_add_u32 s52, s52, 8192
    s_mov_b32 m0, s52
    s_nop 0
    buffer_load_dwordx4 v4, s[20:23], s52 offen lds
    s_add_u32 s52, s52, 8192
    s_mov_b32 m0, s52
    s_nop 0
    buffer_load_dwordx4 v4, s[20:23], s52 offen lds
    s_add_u32 s52, s52, 8192
    s_mov_b32 m0, s52
    s_nop 0
    buffer_load_dwordx4 v4, s[20:23], s52 offen lds
    s_add_u32 s52, s52, 8192
    s_mov_b32 m0, s52
    s_nop 0
    buffer_load_dwordx4 v4, s[20:23], s52 offen lds
    s_add_u32 s52, s52, 8192
    s_mov_b32 m0, s52
    s_nop 0
    buffer_load_dwordx4 v4, s[20:23], s52 offen lds
    s_add_u32 s52, s52, 8192
    s_mov_b32 m0, s52
    s_nop 0
    buffer_load_dwordx4 v4, s[20:23], s52 offen lds
    s_add_u32 s52, s52, 8192
    s_mov_b32 m0, s52
    s_nop 0
    buffer_load_dwordx4 v4, s[20:23], s52 offen lds
    s_add_u32 s52, s52, 8192
    s_mov_b32 m0, s52
    s_nop 0
    buffer_load_dwordx4 v4, s[20:23], s52 offen lds
    s_add_u32 s52, s52, 8192
    s_mov_b32 m0, s52
    s_nop 0
    buffer_load_dwordx4 v4, s[20:23], s52 offen lds
    s_add_u32 s52, s52, 8192
    s_mov_b32 m0, s52
    s_nop 0
    buffer_load_dwordx4 v4, s[20:23], s52 offen lds
    s_add_u32 s52, s52, 8192
    s_mov_b32 m0, s52
    s_nop 0
    buffer_load_dwordx4 v4, s[20:23], s52 offen lds
    s_add_u32 s52, s52, 8192
    s_mov_b32 m0, s52
    s_nop 0
    buffer_load_dwordx4 v4, s[20:23], s52 offen lds
    s_add_u32 s52, s52, 8192
    s_waitcnt vmcnt(12)
    s_barrier
    ds_read_b64_tr_b16 v[212:213], v128 offset:0
    ds_read_b64_tr_b16 v[214:215], v128 offset:1024
    ds_read_b64_tr_b16 v[216:217], v129 offset:0
    ds_read_b64_tr_b16 v[218:219], v129 offset:1024
    ds_read_b64_tr_b16 v[220:221], v130 offset:0
    ds_read_b64_tr_b16 v[222:223], v130 offset:1024
    ds_read_b64_tr_b16 v[224:225], v131 offset:0
    ds_read_b64_tr_b16 v[226:227], v131 offset:1024
    s_lshr_b32 s63, s69, 5
    s_mul_i32 s62, s3, 14
    s_mul_i32 s63, s63, 224
    s_add_u32 s62, s62, s63
    s_lshl_b32 s62, s62, 10
    s_add_u32 s63, s62, 114688
    s_add_u32 s56, s62, 8192
    s_add_u32 s57, s63, 8192
    s_add_u32 s58, s62, 12288
    s_add_u32 s59, s63, 12288
    s_add_u32 s36, s16, 13631488
    s_addc_u32 s37, s17, 0
    s_mov_b32 s38, 1605632
    s_mov_b32 s39, 0x00020000
    ds_read_b64_tr_b16 v[228:229], v136 offset:0
    ds_read_b64_tr_b16 v[230:231], v136 offset:1024
    ds_read_b64_tr_b16 v[232:233], v137 offset:0
    ds_read_b64_tr_b16 v[234:235], v137 offset:1024
    ds_read_b64_tr_b16 v[236:237], v138 offset:0
    ds_read_b64_tr_b16 v[238:239], v138 offset:1024
    ds_read_b64_tr_b16 v[240:241], v139 offset:0
    ds_read_b64_tr_b16 v[242:243], v139 offset:1024
    s_waitcnt lgkmcnt(8)
    v_mfma_f32_32x32x16_bf16 v[148:163], v[12:15], v[212:215], v[148:163]
    v_lshlrev_b32 v248, 16, v212
    v_and_b32 v249, 0xffff0000, v212
    v_add_f32 v244, v244, v248
    v_fmac_f32 v245, v248, v248
    v_add_f32 v246, v246, v249
    v_fmac_f32 v247, v249, v249
    v_mfma_f32_32x32x16_bf16 v[164:179], v[12:15], v[216:219], v[164:179]
    v_lshlrev_b32 v248, 16, v213
    v_and_b32 v249, 0xffff0000, v213
    v_add_f32 v244, v244, v248
    v_fmac_f32 v245, v248, v248
    v_add_f32 v246, v246, v249
    v_fmac_f32 v247, v249, v249
    v_mfma_f32_32x32x16_bf16 v[180:195], v[12:15], v[220:223], v[180:195]
    v_lshlrev_b32 v248, 16, v214
    v_and_b32 v249, 0xffff0000, v214
    v_add_f32 v244, v244, v248
    v_fmac_f32 v245, v248, v248
    v_add_f32 v246, v246, v249
    v_fmac_f32 v247, v249, v249
    v_mfma_f32_32x32x16_bf16 v[196:211], v[12:15], v[224:227], v[196:211]
    v_lshlrev_b32 v248, 16, v215
    v_and_b32 v249, 0xffff0000, v215
    v_add_f32 v244, v244, v248
    v_fmac_f32 v245, v248, v248
    v_add_f32 v246, v246, v249
    v_fmac_f32 v247, v249, v249
    ds_read_b64_tr_b16 v[212:213], v128 offset:8192
    ds_read_b64_tr_b16 v[214:215], v128 offset:9216
    ds_read_b64_tr_b16 v[216:217], v129 offset:8192
    ds_read_b64_tr_b16 v[218:219], v129 offset:9216
    ds_read_b64_tr_b16 v[220:221], v130 offset:8192
    ds_read_b64_tr_b16 v[222:223], v130 offset:9216
    ds_read_b64_tr_b16 v[224:225], v131 offset:8192
    ds_read_b64_tr_b16 v[226:227], v131 offset:9216
    s_waitcnt lgkmcnt(8)
    v_mfma_f32_32x32x16_bf16 v[148:163], v[16:19], v[228:231], v[148:163]
    buffer_load_dwordx4 v[60:63], v5, s[24:27], s60 offen offset:0
    v_mfma_f32_32x32x16_bf16 v[164:179], v[16:19], v[232:235], v[164:179]
    buffer_load_dwordx4 v[64:67], v5, s[24:27], s61 offen offset:1024
    v_mfma_f32_32x32x16_bf16 v[180:195], v[16:19], v[236:239], v[180:195]
    buffer_load_dwordx4 v[68:71], v5, s[24:27], s60 offen offset:2048
    v_mfma_f32_32x32x16_bf16 v[196:211], v[16:19], v[240:243], v[196:211]
    buffer_load_dwordx4 v[72:75], v5, s[24:27], s61 offen offset:3072
    s_add_u32 s60, s60, 4096
    s_add_u32 s61, s61, 4096
    ds_read_b64_tr_b16 v[228:229], v136 offset:8192
    ds_read_b64_tr_b16 v[230:231], v136 offset:9216
    ds_read_b64_tr_b16 v[232:233], v137 offset:8192
    ds_read_b64_tr_b16 v[234:235], v137 offset:9216
    ds_read_b64_tr_b16 v[236:237], v138 offset:8192
    ds_read_b64_tr_b16 v[238:239], v138 offset:9216
    ds_read_b64_tr_b16 v[240:241], v139 offset:8192
    ds_read_b64_tr_b16 v[242:243], v139 offset:9216
    s_waitcnt lgkmcnt(8)
    v_mfma_f32_32x32x16_bf16 v[148:163], v[20:23], v[212:215], v[148:163]
    v_lshlrev_b32 v248, 16, v212
    v_and_b32 v249, 0xffff0000, v212
    v_add_f32 v244, v244, v248
    v_fmac_f32 v245, v248, v248
    v_add_f32 v246, v246, v249
    v_fmac_f32 v247, v249, v249
    v_mfma_f32_32x32x16_bf16 v[164:179], v[20:23], v[216:219], v[164:179]
    v_lshlrev_b32 v248, 16, v213
    v_and_b32 v249, 0xffff0000, v213
    v_add_f32 v244, v244, v248
    v_fmac_f32 v245, v248, v248
    v_add_f32 v246, v246, v249
    v_fmac_f32 v247, v249, v249
    v_mfma_f32_32x32x16_bf16 v[180:195], v[20:23], v[220:223], v[180:195]
    v_lshlrev_b32 v248, 16, v214
    v_and_b32 v249, 0xffff0000, v214
    v_add_f32 v244, v244, v248
    v_fmac_f32 v245, v248, v248
    v_add_f32 v246, v246, v249
    v_fmac_f32 v247, v249, v249
    v_mfma_f32_32x32x16_bf16 v[196:211], v[20:23], v[224:227], v[196:211]
    v_lshlrev_b32 v248, 16, v215
    v_and_b32 v249, 0xffff0000, v215
    v_add_f32 v244, v244, v248
    v_fmac_f32 v245, v248, v248
    v_add_f32 v246, v246, v249
    v_fmac_f32 v247, v249, v249
    s_waitcnt vmcnt(12)
    s_barrier
    ds_read_b64_tr_b16 v[212:213], v128 offset:16384
    ds_read_b64_tr_b16 v[214:215], v128 offset:17408
    ds_read_b64_tr_b16 v[216:217], v129 offset:16384
    ds_read_b64_tr_b16 v[218:219], v129 offset:17408
    ds_read_b64_tr_b16 v[220:221], v130 offset:16384
    ds_read_b64_tr_b16 v[222:223], v130 offset:17408
    ds_read_b64_tr_b16 v[224:225], v131 offset:16384
    ds_read_b64_tr_b16 v[226:227], v131 offset:17408
    s_waitcnt lgkmcnt(8)
    v_mfma_f32_32x32x16_bf16 v[148:163], v[24:27], v[228:231], v[148:163]
    buffer_load_dwordx4 v[76:79], v5, s[24:27], s60 offen offset:0
    v_mfma_f32_32x32x16_bf16 v[164:179], v[24:27], v[232:235], v[164:179]
    buffer_load_dwordx4 v[80:83], v5, s[24:27], s61 offen offset:1024
    v_mfma_f32_32x32x16_bf16 v[180:195], v[24:27], v[236:239], v[180:195]
    buffer_load_dwordx4 v[84:87], v5, s[24:27], s60 offen offset:2048
    v_mfma_f32_32x32x16_bf16 v[196:211], v[24:27], v[240:243], v[196:211]
    buffer_load_dwordx4 v[88:91], v5, s[24:27], s61 offen offset:3072
    s_add_u32 s60, s60, 4096
    s_add_u32 s61, s61, 4096
    ds_read_b64_tr_b16 v[228:229], v136 offset:16384
    ds_read_b64_tr_b16 v[230:231], v136 offset:17408
    ds_read_b64_tr_b16 v[232:233], v137 offset:16384
    ds_read_b64_tr_b16 v[234:235], v137 offset:17408
    ds_read_b64_tr_b16 v[236:237], v138 offset:16384
    ds_read_b64_tr_b16 v[238:239], v138 offset:17408
    ds_read_b64_tr_b16 v[240:241], v139 offset:16384
    ds_read_b64_tr_b16 v[242:243], v139 offset:17408
    s_waitcnt lgkmcnt(8)
    v_mfma_f32_32x32x16_bf16 v[148:163], v[28:31], v[212:215], v[148:163]
    v_lshlrev_b32 v248, 16, v212
    v_and_b32 v249, 0xffff0000, v212
    v_add_f32 v244, v244, v248
    v_fmac_f32 v245, v248, v248
    v_add_f32 v246, v246, v249
    v_fmac_f32 v247, v249, v249
    v_mfma_f32_32x32x16_bf16 v[164:179], v[28:31], v[216:219], v[164:179]
    v_lshlrev_b32 v248, 16, v213
    v_and_b32 v249, 0xffff0000, v213
    v_add_f32 v244, v244, v248
    v_fmac_f32 v245, v248, v248
    v_add_f32 v246, v246, v249
    v_fmac_f32 v247, v249, v249
    v_mfma_f32_32x32x16_bf16 v[180:195], v[28:31], v[220:223], v[180:195]
    v_lshlrev_b32 v248, 16, v214
    v_and_b32 v249, 0xffff0000, v214
    v_add_f32 v244, v244, v248
    v_fmac_f32 v245, v248, v248
    v_add_f32 v246, v246, v249
    v_fmac_f32 v247, v249, v249
    v_mfma_f32_32x32x16_bf16 v[196:211], v[28:31], v[224:227], v[196:211]
    v_lshlrev_b32 v248, 16, v215
    v_and_b32 v249, 0xffff0000, v215
    v_add_f32 v244, v244, v248
    v_fmac_f32 v245, v248, v248
    v_add_f32 v246, v246, v249
    v_fmac_f32 v247, v249, v249
    ds_read_b64_tr_b16 v[212:213], v128 offset:24576
    ds_read_b64_tr_b16 v[214:215], v128 offset:25600
    ds_read_b64_tr_b16 v[216:217], v129 offset:24576
    ds_read_b64_tr_b16 v[218:219], v129 offset:25600
    ds_read_b64_tr_b16 v[220:221], v130 offset:24576
    ds_read_b64_tr_b16 v[222:223], v130 offset:25600
    ds_read_b64_tr_b16 v[224:225], v131 offset:24576
    ds_read_b64_tr_b16 v[226:227], v131 offset:25600
    s_waitcnt lgkmcnt(8)
    v_mfma_f32_32x32x16_bf16 v[148:163], v[32:35], v[228:231], v[148:163]
    buffer_load_dwordx4 v[92:95], v5, s[24:27], s60 offen offset:0
    v_mfma_f32_32x32x16_bf16 v[164:179], v[32:35], v[232:235], v[164:179]
    buffer_load_dwordx4 v[96:99], v5, s[24:27], s61 offen offset:1024
    v_mfma_f32_32x32x16_bf16 v[180:195], v[32:35], v[236:239], v[180:195]
    buffer_load_dwordx4 v[100:103], v5, s[24:27], s60 offen offset:2048
    v_mfma_f32_32x32x16_bf16 v[196:211], v[32:35], v[240:243], v[196:211]
    buffer_load_dwordx4 v[104:107], v5, s[24:27], s61 offen offset:3072
    s_add_u32 s60, s60, 4096
    s_add_u32 s61, s61, 4096
    ds_read_b64_tr_b16 v[228:229], v136 offset:24576
    ds_read_b64_tr_b16 v[230:231], v136 offset:25600
    ds_read_b64_tr_b16 v[232:233], v137 offset:24576
    ds_read_b64_tr_b16 v[234:235], v137 offset:25600
    ds_read_b64_tr_b16 v[236:237], v138 offset:24576
    ds_read_b64_tr_b16 v[238:239], v138 offset:25600
    ds_read_b64_tr_b16 v[240:241], v139 offset:24576
    ds_read_b64_tr_b16 v[242:243], v139 offset:25600
    s_waitcnt lgkmcnt(8)
    v_mfma_f32_32x32x16_bf16 v[148:163], v[36:39], v[212:215], v[148:163]
    v_lshlrev_b32 v248, 16, v212
    v_and_b32 v249, 0xffff0000, v212
    v_add_f32 v244, v244, v248
    v_fmac_f32 v245, v248, v248
    v_add_f32 v246, v246, v249
    v_fmac_f32 v247, v249, v249
    v_mfma_f32_32x32x16_bf16 v[164:179], v[36:39], v[216:219], v[164:179]
    v_lshlrev_b32 v248, 16, v213
    v_and_b32 v249, 0xffff0000, v213
    v_add_f32 v244, v244, v248
    v_fmac_f32 v245, v248, v248
    v_add_f32 v246, v246, v249
    v_fmac_f32 v247, v249, v249
    v_mfma_f32_32x32x16_bf16 v[180:195], v[36:39], v[220:223], v[180:195]
    v_lshlrev_b32 v248, 16, v214
    v_and_b32 v249, 0xffff0000, v214
    v_add_f32 v244, v244, v248
    v_fmac_f32 v245, v248, v248
    v_add_f32 v246, v246, v249
    v_fmac_f32 v247, v249, v249
    v_mfma_f32_32x32x16_bf16 v[196:211], v[36:39], v[224:227], v[196:211]
    v_lshlrev_b32 v248, 16, v215
    v_and_b32 v249, 0xffff0000, v215
    v_add_f32 v244, v244, v248
    v_fmac_f32 v245, v248, v248
    v_add_f32 v246, v246, v249
    v_fmac_f32 v247, v249, v249
    ds_read_b64_tr_b16 v[212:213], v128 offset:32768
    ds_read_b64_tr_b16 v[214:215], v128 offset:33792
    ds_read_b64_tr_b16 v[216:217], v129 offset:32768
    ds_read_b64_tr_b16 v[218:219], v129 offset:33792
    ds_read_b64_tr_b16 v[220:221], v130 offset:32768
    ds_read_b64_tr_b16 v[222:223], v130 offset:33792
    ds_read_b64_tr_b16 v[224:225], v131 offset:32768
    ds_read_b64_tr_b16 v[226:227], v131 offset:33792
    s_waitcnt lgkmcnt(8)
    v_mfma_f32_32x32x16_bf16 v[148:163], v[40:43], v[228:231], v[148:163]
    buffer_load_dwordx4 v[108:111], v5, s[24:27], s60 offen offset:0
    v_mfma_f32_32x32x16_bf16 v[164:179], v[40:43], v[232:235], v[164:179]
    buffer_load_dwordx4 v[112:115], v5, s[24:27], s61 offen offset:1024
    v_mfma_f32_32x32x16_bf16 v[180:195], v[40:43], v[236:239], v[180:195]
    buffer_load_dwordx4 v[116:119], v5, s[24:27], s60 offen offset:2048
    v_mfma_f32_32x32x16_bf16 v[196:211], v[40:43], v[240:243], v[196:211]
    buffer_load_dwordx4 v[120:123], v5, s[24:27], s61 offen offset:3072
    s_add_u32 s60, s60, 4096
    s_add_u32 s61, s61, 4096
    ds_read_b64_tr_b16 v[228:229], v136 offset:32768
    ds_read_b64_tr_b16 v[230:231], v136 offset:33792
    ds_read_b64_tr_b16 v[232:233], v137 offset:32768
    ds_read_b64_tr_b16 v[234:235], v137 offset:33792
    ds_read_b64_tr_b16 v[236:237], v138 offset:32768
    ds_read_b64_tr_b16 v[238:239], v138 offset:33792
    ds_read_b64_tr_b16 v[240:241], v139 offset:32768
    ds_read_b64_tr_b16 v[242:243], v139 offset:33792
    s_waitcnt lgkmcnt(8)
    v_mfma_f32_32x32x16_bf16 v[148:163], v[44:47], v[212:215], v[148:163]
    v_lshlrev_b32 v248, 16, v212
    v_and_b32 v249, 0xffff0000, v212
    v_add_f32 v244, v244, v248
    v_fmac_f32 v245, v248, v248
    v_add_f32 v246, v246, v249
    v_fmac_f32 v247, v249, v249
    v_mfma_f32_32x32x16_bf16 v[164:179], v[44:47], v[216:219], v[164:179]
    v_lshlrev_b32 v248, 16, v213
    v_and_b32 v249, 0xffff0000, v213
    v_add_f32 v244, v244, v248
    v_fmac_f32 v245, v248, v248
    v_add_f32 v246, v246, v249
    v_fmac_f32 v247, v249, v249
    v_mfma_f32_32x32x16_bf16 v[180:195], v[44:47], v[220:223], v[180:195]
    v_lshlrev_b32 v248, 16, v214
    v_and_b32 v249, 0xffff0000, v214
    v_add_f32 v244, v244, v248
    v_fmac_f32 v245, v248, v248
    v_add_f32 v246, v246, v249
    v_fmac_f32 v247, v249, v249
    v_mfma_f32_32x32x16_bf16 v[196:211], v[44:47], v[224:227], v[196:211]
    v_lshlrev_b32 v248, 16, v215
    v_and_b32 v249, 0xffff0000, v215
    v_add_f32 v244, v244, v248
    v_fmac_f32 v245, v248, v248
    v_add_f32 v246, v246, v249
    v_fmac_f32 v247, v249, v249
    s_waitcnt vmcnt(16)
    s_barrier
    buffer_load_dword v12, v124, s[28:31], s55 offen
    buffer_load_dword v13, v124, s[28:31], s55 offen offset:32
    ds_read_b64_tr_b16 v[212:213], v128 offset:40960
    ds_read_b64_tr_b16 v[214:215], v128 offset:41984
    ds_read_b64_tr_b16 v[216:217], v129 offset:40960
    ds_read_b64_tr_b16 v[218:219], v129 offset:41984
    ds_read_b64_tr_b16 v[220:221], v130 offset:40960
    ds_read_b64_tr_b16 v[222:223], v130 offset:41984
    ds_read_b64_tr_b16 v[224:225], v131 offset:40960
    ds_read_b64_tr_b16 v[226:227], v131 offset:41984
    s_waitcnt lgkmcnt(8)
    v_mfma_f32_32x32x16_bf16 v[148:163], v[48:51], v[228:231], v[148:163]
    v_mfma_f32_32x32x16_bf16 v[164:179], v[48:51], v[232:235], v[164:179]
    v_mfma_f32_32x32x16_bf16 v[180:195], v[48:51], v[236:239], v[180:195]
    v_mfma_f32_32x32x16_bf16 v[196:211], v[48:51], v[240:243], v[196:211]
    s_lshr_b32 s48, s69, 3
    s_lshl_b32 s48, s48, 3
    s_add_u32 s48, s48, s3
    s_lshl_b32 s48, s48, 13
    v_lshlrev_b32 v2, 7, v1
    buffer_load_dword v145, v2, s[36:39], s48 offen
    ds_read_b64_tr_b16 v[228:229], v136 offset:40960
    ds_read_b64_tr_b16 v[230:231], v136 offset:41984
    ds_read_b64_tr_b16 v[232:233], v137 offset:40960
    ds_read_b64_tr_b16 v[234:235], v137 offset:41984
    ds_read_b64_tr_b16 v[236:237], v138 offset:40960
    ds_read_b64_tr_b16 v[238:239], v138 offset:41984
    ds_read_b64_tr_b16 v[240:241], v139 offset:40960
    ds_read_b64_tr_b16 v[242:243], v139 offset:41984
    s_waitcnt lgkmcnt(8)
    v_mfma_f32_32x32x16_bf16 v[148:163], v[52:55], v[212:215], v[148:163]
    v_lshlrev_b32 v248, 16, v212
    v_and_b32 v249, 0xffff0000, v212
    v_add_f32 v244, v244, v248
    v_fmac_f32 v245, v248, v248
    v_add_f32 v246, v246, v249
    v_fmac_f32 v247, v249, v249
    v_mfma_f32_32x32x16_bf16 v[164:179], v[52:55], v[216:219], v[164:179]
    v_lshlrev_b32 v248, 16, v213
    v_and_b32 v249, 0xffff0000, v213
    v_add_f32 v244, v244, v248
    v_fmac_f32 v245, v248, v248
    v_add_f32 v246, v246, v249
    v_fmac_f32 v247, v249, v249
    v_mfma_f32_32x32x16_bf16 v[180:195], v[52:55], v[220:223], v[180:195]
    v_lshlrev_b32 v248, 16, v214
    v_and_b32 v249, 0xffff0000, v214
    v_add_f32 v244, v244, v248
    v_fmac_f32 v245, v248, v248
    v_add_f32 v246, v246, v249
    v_fmac_f32 v247, v249, v249
    v_mfma_f32_32x32x16_bf16 v[196:211], v[52:55], v[224:227], v[196:211]
    v_lshlrev_b32 v248, 16, v215
    v_and_b32 v249, 0xffff0000, v215
    v_add_f32 v244, v244, v248
    v_fmac_f32 v245, v248, v248
    v_add_f32 v246, v246, v249
    v_fmac_f32 v247, v249, v249
    s_waitcnt lgkmcnt(0)
    v_mfma_f32_32x32x16_bf16 v[148:163], v[56:59], v[228:231], v[148:163]
    v_mfma_f32_32x32x16_bf16 v[164:179], v[56:59], v[232:235], v[164:179]
    v_mfma_f32_32x32x16_bf16 v[180:195], v[56:59], v[236:239], v[180:195]
    v_mfma_f32_32x32x16_bf16 v[196:211], v[56:59], v[240:243], v[196:211]
    s_waitcnt vmcnt(3)
    ds_read_b64_tr_b16 v[212:213], v128 offset:49152
    ds_read_b64_tr_b16 v[214:215], v128 offset:50176
    ds_read_b64_tr_b16 v[216:217], v136 offset:49152
    ds_read_b64_tr_b16 v[218:219], v136 offset:50176
    ds_read_b64_tr_b16 v[220:221], v128 offset:57344
    ds_read_b64_tr_b16 v[222:223], v128 offset:58368
    s_waitcnt lgkmcnt(4)
    v_mfma_f32_32x32x16_bf16 v[148:163], v[60:63], v[212:215], v[148:163]
    v_lshlrev_b32 v248, 16, v212
    v_and_b32 v249, 0xffff0000, v212
    v_add_f32 v244, v244, v248
    v_fmac_f32 v245, v248, v248
    v_add_f32 v246, v246, v249
    v_fmac_f32 v247, v249, v249
    v_lshlrev_b32 v248, 16, v213
    v_and_b32 v249, 0xffff0000, v213
    v_add_f32 v244, v244, v248
    v_fmac_f32 v245, v248, v248
    v_add_f32 v246, v246, v249
    v_fmac_f32 v247, v249, v249
    v_lshlrev_b32 v248, 16, v214
    v_and_b32 v249, 0xffff0000, v214
    v_add_f32 v244, v244, v248
    v_fmac_f32 v245, v248, v248
    v_add_f32 v246, v246, v249
    v_fmac_f32 v247, v249, v249
    v_lshlrev_b32 v248, 16, v215
    v_and_b32 v249, 0xffff0000, v215
    v_add_f32 v244, v244, v248
    v_fmac_f32 v245, v248, v248
    v_add_f32 v246, v246, v249
    v_fmac_f32 v247, v249, v249
    ds_read_b64_tr_b16 v[224:225], v136 offset:57344
    ds_read_b64_tr_b16 v[226:227], v136 offset:58368
    s_waitcnt lgkmcnt(4)
    v_mfma_f32_32x32x16_bf16 v[148:163], v[64:67], v[216:219], v[148:163]
    ds_read_b64_tr_b16 v[212:213], v132 offset:0
    ds_read_b64_tr_b16 v[214:215], v132 offset:1024
    s_waitcnt lgkmcnt(4)
    v_mfma_f32_32x32x16_bf16 v[148:163], v[68:71], v[220:223], v[148:163]
    v_lshlrev_b32 v248, 16, v220
    v_and_b32 v249, 0xffff0000, v220
    v_add_f32 v244, v244, v248
    v_fmac_f32 v245, v248, v248
    v_add_f32 v246, v246, v249
    v_fmac_f32 v247, v249, v249
    v_lshlrev_b32 v248, 16, v221
    v_and_b32 v249, 0xffff0000, v221
    v_add_f32 v244, v244, v248
    v_fmac_f32 v245, v248, v248
    v_add_f32 v246, v246, v249
    v_fmac_f32 v247, v249, v249
    v_lshlrev_b32 v248, 16, v222
    v_and_b32 v249, 0xffff0000, v222
    v_add_f32 v244, v244, v248
    v_fmac_f32 v245, v248, v248
    v_add_f32 v246, v246, v249
    v_fmac_f32 v247, v249, v249
    v_lshlrev_b32 v248, 16, v223
    v_and_b32 v249, 0xffff0000, v223
    v_add_f32 v244, v244, v248
    v_fmac_f32 v245, v248, v248
    v_add_f32 v246, v246, v249
    v_fmac_f32 v247, v249, v249
    ds_read_b64_tr_b16 v[216:217], v140 offset:0
    ds_read_b64_tr_b16 v[218:219], v140 offset:1024
    s_waitcnt lgkmcnt(4)
    v_mfma_f32_32x32x16_bf16 v[148:163], v[72:75], v[224:227], v[148:163]
    ds_read_b64_tr_b16 v[220:221], v132 offset:8192
    ds_read_b64_tr_b16 v[222:223], v132 offset:9216
    s_waitcnt lgkmcnt(4)
    v_mfma_f32_32x32x16_bf16 v[148:163], v[76:79], v[212:215], v[148:163]
    v_lshlrev_b32 v248, 16, v212
    v_and_b32 v249, 0xffff0000, v212
    v_add_f32 v244, v244, v248
    v_fmac_f32 v245, v248, v248
    v_add_f32 v246, v246, v249
    v_fmac_f32 v247, v249, v249
    v_lshlrev_b32 v248, 16, v213
    v_and_b32 v249, 0xffff0000, v213
    v_add_f32 v244, v244, v248
    v_fmac_f32 v245, v248, v248
    v_add_f32 v246, v246, v249
    v_fmac_f32 v247, v249, v249
    v_lshlrev_b32 v248, 16, v214
    v_and_b32 v249, 0xffff0000, v214
    v_add_f32 v244, v244, v248
    v_fmac_f32 v245, v248, v248
    v_add_f32 v246, v246, v249
    v_fmac_f32 v247, v249, v249
    v_lshlrev_b32 v248, 16, v215
    v_and_b32 v249, 0xffff0000, v215
    v_add_f32 v244, v244, v248
    v_fmac_f32 v245, v248, v248
    v_add_f32 v246, v246, v249
    v_fmac_f32 v247, v249, v249
    ds_read_b64_tr_b16 v[224:225], v140 offset:8192
    ds_read_b64_tr_b16 v[226:227], v140 offset:9216
    s_waitcnt lgkmcnt(4)
    v_mfma_f32_32x32x16_bf16 v[148:163], v[80:83], v[216:219], v[148:163]
    ds_read_b64_tr_b16 v[212:213], v132 offset:16384
    ds_read_b64_tr_b16 v[214:215], v132 offset:17408
    s_waitcnt lgkmcnt(4)
    v_mfma_f32_32x32x16_bf16 v[148:163], v[84:87], v[220:223], v[148:163]
    v_lshlrev_b32 v248, 16, v220
    v_and_b32 v249, 0xffff0000, v220
    v_add_f32 v244, v244, v248
    v_fmac_f32 v245, v248, v248
    v_add_f32 v246, v246, v249
    v_fmac_f32 v247, v249, v249
    v_lshlrev_b32 v248, 16, v221
    v_and_b32 v249, 0xffff0000, v221
    v_add_f32 v244, v244, v248
    v_fmac_f32 v245, v248, v248
    v_add_f32 v246, v246, v249
    v_fmac_f32 v247, v249, v249
    v_lshlrev_b32 v248, 16, v222
    v_and_b32 v249, 0xffff0000, v222
    v_add_f32 v244, v244, v248
    v_fmac_f32 v245, v248, v248
    v_add_f32 v246, v246, v249
    v_fmac_f32 v247, v249, v249
    v_lshlrev_b32 v248, 16, v223
    v_and_b32 v249, 0xffff0000, v223
    v_add_f32 v244, v244, v248
    v_fmac_f32 v245, v248, v248
    v_add_f32 v246, v246, v249
    v_fmac_f32 v247, v249, v249
    ds_read_b64_tr_b16 v[216:217], v140 offset:16384
    ds_read_b64_tr_b16 v[218:219], v140 offset:17408
    s_waitcnt lgkmcnt(4)
    v_mfma_f32_32x32x16_bf16 v[148:163], v[88:91], v[224:227], v[148:163]
    ds_read_b64_tr_b16 v[220:221], v132 offset:24576
    ds_read_b64_tr_b16 v[222:223], v132 offset:25600
    s_waitcnt lgkmcnt(4)
    v_mfma_f32_32x32x16_bf16 v[148:163], v[92:95], v[212:215], v[148:163]
    v_lshlrev_b32 v248, 16, v212
    v_and_b32 v249, 0xffff0000, v212
    v_add_f32 v244, v244, v248
    v_fmac_f32 v245, v248, v248
    v_add_f32 v246, v246, v249
    v_fmac_f32 v247, v249, v249
    v_lshlrev_b32 v248, 16, v213
    v_and_b32 v249, 0xffff0000, v213
    v_add_f32 v244, v244, v248
    v_fmac_f32 v245, v248, v248
    v_add_f32 v246, v246, v249
    v_fmac_f32 v247, v249, v249
    v_lshlrev_b32 v248, 16, v214
    v_and_b32 v249, 0xffff0000, v214
    v_add_f32 v244, v244, v248
    v_fmac_f32 v245, v248, v248
    v_add_f32 v246, v246, v249
    v_fmac_f32 v247, v249, v249
    v_lshlrev_b32 v248, 16, v215
    v_and_b32 v249, 0xffff0000, v215
    v_add_f32 v244, v244, v248
    v_fmac_f32 v245, v248, v248
    v_add_f32 v246, v246, v249
    v_fmac_f32 v247, v249, v249
    ds_read_b64_tr_b16 v[224:225], v140 offset:24576
    ds_read_b64_tr_b16 v[226:227], v140 offset:25600
    s_waitcnt lgkmcnt(4)
    v_mfma_f32_32x32x16_bf16 v[148:163], v[96:99], v[216:219], v[148:163]
    ds_read_b64_tr_b16 v[212:213], v132 offset:32768
    ds_read_b64_tr_b16 v[214:215], v132 offset:33792
    s_waitcnt lgkmcnt(4)
    v_mfma_f32_32x32x16_bf16 v[148:163], v[100:103], v[220:223], v[148:163]
    v_lshlrev_b32 v248, 16, v220
    v_and_b32 v249, 0xffff0000, v220
    v_add_f32 v244, v244, v248
    v_fmac_f32 v245, v248, v248
    v_add_f32 v246, v246, v249
    v_fmac_f32 v247, v249, v249
    v_lshlrev_b32 v248, 16, v221
    v_and_b32 v249, 0xffff0000, v221
    v_add_f32 v244, v244, v248
    v_fmac_f32 v245, v248, v248
    v_add_f32 v246, v246, v249
    v_fmac_f32 v247, v249, v249
    v_lshlrev_b32 v248, 16, v222
    v_and_b32 v249, 0xffff0000, v222
    v_add_f32 v244, v244, v248
    v_fmac_f32 v245, v248, v248
    v_add_f32 v246, v246, v249
    v_fmac_f32 v247, v249, v249
    v_lshlrev_b32 v248, 16, v223
    v_and_b32 v249, 0xffff0000, v223
    v_add_f32 v244, v244, v248
    v_fmac_f32 v245, v248, v248
    v_add_f32 v246, v246, v249
    v_fmac_f32 v247, v249, v249
    ds_read_b64_tr_b16 v[216:217], v140 offset:32768
    ds_read_b64_tr_b16 v[218:219], v140 offset:33792
    s_waitcnt lgkmcnt(4)
    v_mfma_f32_32x32x16_bf16 v[148:163], v[104:107], v[224:227], v[148:163]
    ds_read_b64_tr_b16 v[220:221], v132 offset:40960
    ds_read_b64_tr_b16 v[222:223], v132 offset:41984
    s_waitcnt lgkmcnt(4)
    v_mfma_f32_32x32x16_bf16 v[148:163], v[108:111], v[212:215], v[148:163]
    v_lshlrev_b32 v248, 16, v212
    v_and_b32 v249, 0xffff0000, v212
    v_add_f32 v244, v244, v248
    v_fmac_f32 v245, v248, v248
    v_add_f32 v246, v246, v249
    v_fmac_f32 v247, v249, v249
    v_lshlrev_b32 v248, 16, v213
    v_and_b32 v249, 0xffff0000, v213
    v_add_f32 v244, v244, v248
    v_fmac_f32 v245, v248, v248
    v_add_f32 v246, v246, v249
    v_fmac_f32 v247, v249, v249
    v_lshlrev_b32 v248, 16, v214
    v_and_b32 v249, 0xffff0000, v214
    v_add_f32 v244, v244, v248
    v_fmac_f32 v245, v248, v248
    v_add_f32 v246, v246, v249
    v_fmac_f32 v247, v249, v249
    v_lshlrev_b32 v248, 16, v215
    v_and_b32 v249, 0xffff0000, v215
    v_add_f32 v244, v244, v248
    v_fmac_f32 v245, v248, v248
    v_add_f32 v246, v246, v249
    v_fmac_f32 v247, v249, v249
    ds_read_b64_tr_b16 v[224:225], v140 offset:40960
    ds_read_b64_tr_b16 v[226:227], v140 offset:41984
    s_waitcnt lgkmcnt(4)
    v_mfma_f32_32x32x16_bf16 v[148:163], v[112:115], v[216:219], v[148:163]
    ds_read_b64_tr_b16 v[212:213], v129 offset:49152
    ds_read_b64_tr_b16 v[214:215], v129 offset:50176
    s_waitcnt lgkmcnt(4)
    v_mfma_f32_32x32x16_bf16 v[148:163], v[116:119], v[220:223], v[148:163]
    v_lshlrev_b32 v248, 16, v220
    v_and_b32 v249, 0xffff0000, v220
    v_add_f32 v244, v244, v248
    v_fmac_f32 v245, v248, v248
    v_add_f32 v246, v246, v249
    v_fmac_f32 v247, v249, v249
    v_lshlrev_b32 v248, 16, v221
    v_and_b32 v249, 0xffff0000, v221
    v_add_f32 v244, v244, v248
    v_fmac_f32 v245, v248, v248
    v_add_f32 v246, v246, v249
    v_fmac_f32 v247, v249, v249
    v_lshlrev_b32 v248, 16, v222
    v_and_b32 v249, 0xffff0000, v222
    v_add_f32 v244, v244, v248
    v_fmac_f32 v245, v248, v248
    v_add_f32 v246, v246, v249
    v_fmac_f32 v247, v249, v249
    v_lshlrev_b32 v248, 16, v223
    v_and_b32 v249, 0xffff0000, v223
    v_add_f32 v244, v244, v248
    v_fmac_f32 v245, v248, v248
    v_add_f32 v246, v246, v249
    v_fmac_f32 v247, v249, v249
    ds_read_b64_tr_b16 v[216:217], v137 offset:49152
    ds_read_b64_tr_b16 v[218:219], v137 offset:50176
    s_waitcnt lgkmcnt(4)
    v_mfma_f32_32x32x16_bf16 v[148:163], v[120:123], v[224:227], v[148:163]
    ds_read_b64_tr_b16 v[220:221], v129 offset:57344
    ds_read_b64_tr_b16 v[222:223], v129 offset:58368
    s_waitcnt lgkmcnt(4)
    v_mfma_f32_32x32x16_bf16 v[164:179], v[60:63], v[212:215], v[164:179]
    ds_read_b64_tr_b16 v[224:225], v137 offset:57344
    ds_read_b64_tr_b16 v[226:227], v137 offset:58368
    s_waitcnt lgkmcnt(4)
    v_mfma_f32_32x32x16_bf16 v[164:179], v[64:67], v[216:219], v[164:179]
    s_lshl_b32 s48, s3, 9
    v_lshlrev_b32 v2, 3, v1
    v_add_u32 v2, s48, v2
    v_add_u32 v2, 114688, v2
    v_add_f32 v244, v244, v246
    v_add_f32 v245, v245, v247
    ds_write_b64 v2, v[244:245]
    s_waitcnt lgkmcnt(0)
    s_barrier
    s_add_u32 s48, s3, 0
    s_and_b32 s48, s48, 3
    s_lshl_b32 s48, s48, 9
    s_add_u32 s48, s48, 114688
    v_lshlrev_b32 v2, 3, v7
    v_add_u32 v2, s48, v2
    ds_read2_b64 v[52:55], v2 offset0:0 offset1:32
    v_add_u32 v2, 2048, v2
    ds_read2_b64 v[56:59], v2 offset0:0 offset1:32
    ds_read_b64_tr_b16 v[212:213], v133 offset:0
    ds_read_b64_tr_b16 v[214:215], v133 offset:1024
    s_waitcnt lgkmcnt(4)
    v_mfma_f32_32x32x16_bf16 v[164:179], v[68:71], v[220:223], v[164:179]
    s_waitcnt lgkmcnt(0)
    v_add_f32 v230, v52, v54
    v_add_f32 v234, v53, v55
    v_add_f32 v230, v230, v56
    v_add_f32 v234, v234, v57
    v_add_f32 v230, v230, v58
    v_add_f32 v234, v234, v59
    v_mul_f32 v230, 0x3b124925, v230
    v_mul_f32 v234, 0x3b124925, v234
    v_fma_f32 v234, -v230, v230, v234
    v_max_f32 v234, 0, v234
    s_add_u32 s48, s3, 1
    s_and_b32 s48, s48, 3
    s_lshl_b32 s48, s48, 9
    s_add_u32 s48, s48, 114688
    v_lshlrev_b32 v2, 3, v7
    v_add_u32 v2, s48, v2
    ds_read2_b64 v[52:55], v2 offset0:0 offset1:32
    ds_read_b64_tr_b16 v[216:217], v141 offset:0
    ds_read_b64_tr_b16 v[218:219], v141 offset:1024
    s_waitcnt lgkmcnt(4)
    v_mfma_f32_32x32x16_bf16 v[164:179], v[72:75], v[224:227], v[164:179]
    v_add_u32 v2, 2048, v2
    ds_read2_b64 v[56:59], v2 offset0:0 offset1:32
    s_waitcnt lgkmcnt(0)
    v_add_f32 v231, v52, v54
    v_add_f32 v235, v53, v55
    v_add_f32 v231, v231, v56
    v_add_f32 v235, v235, v57
    v_add_f32 v231, v231, v58
    v_add_f32 v235, v235, v59
    v_mul_f32 v231, 0x3b124925, v231
    v_mul_f32 v235, 0x3b124925, v235
    v_fma_f32 v235, -v231, v231, v235
    v_max_f32 v235, 0, v235
    s_add_u32 s48, s3, 2
    s_and_b32 s48, s48, 3
    s_lshl_b32 s48, s48, 9
    s_add_u32 s48, s48, 114688
    v_lshlrev_b32 v2, 3, v7
    ds_read_b64_tr_b16 v[220:221], v133 offset:8192
    ds_read_b64_tr_b16 v[222:223], v133 offset:9216
    s_waitcnt lgkmcnt(4)
    v_mfma_f32_32x32x16_bf16 v[164:179], v[76:79], v[212:215], v[164:179]
    v_add_u32 v2, s48, v2
    ds_read2_b64 v[52:55], v2 offset0:0 offset1:32
    v_add_u32 v2, 2048, v2
    ds_read2_b64 v[56:59], v2 offset0:0 offset1:32
    s_waitcnt lgkmcnt(0)
    v_add_f32 v232, v52, v54
    v_add_f32 v236, v53, v55
    v_add_f32 v232, v232, v56
    v_add_f32 v236, v236, v57
    v_add_f32 v232, v232, v58
    v_add_f32 v236, v236, v59
    v_mul_f32 v232, 0x3b124925, v232
    v_mul_f32 v236, 0x3b124925, v236
    v_fma_f32 v236, -v232, v232, v236
    v_max_f32 v236, 0, v236
    s_add_u32 s48, s3, 3
    s_and_b32 s48, s48, 3
    s_lshl_b32 s48, s48, 9
    ds_read_b64_tr_b16 v[224:225], v141 offset:8192
    ds_read_b64_tr_b16 v[226:227], v141 offset:9216
    s_waitcnt lgkmcnt(4)
    v_mfma_f32_32x32x16_bf16 v[164:179], v[80:83], v[216:219], v[164:179]
    s_add_u32 s48, s48, 114688
    v_lshlrev_b32 v2, 3, v7
    v_add_u32 v2, s48, v2
    ds_read2_b64 v[52:55], v2 offset0:0 offset1:32
    v_add_u32 v2, 2048, v2
    ds_read2_b64 v[56:59], v2 offset0:0 offset1:32
    s_waitcnt lgkmcnt(0)
    v_add_f32 v233, v52, v54
    v_add_f32 v237, v53, v55
    v_add_f32 v233, v233, v56
    v_add_f32 v237, v237, v57
    v_add_f32 v233, v233, v58
    v_add_f32 v237, v237, v59
    v_mul_f32 v233, 0x3b124925, v233
    v_mul_f32 v237, 0x3b124925, v237
    v_fma_f32 v237, -v233, v233, v237
    v_max_f32 v237, 0, v237
    v_cvt_pk_bf16_f32 v2, v230, v231
    ds_read_b64_tr_b16 v[212:213], v133 offset:16384
    ds_read_b64_tr_b16 v[214:215], v133 offset:17408
    s_waitcnt lgkmcnt(4)
    v_mfma_f32_32x32x16_bf16 v[164:179], v[84:87], v[220:223], v[164:179]
    v_lshlrev_b32 v230, 16, v2
    v_and_b32 v231, 0xffff0000, v2
    v_cvt_pk_bf16_f32 v3, v234, v235
    v_lshlrev_b32 v234, 16, v3
    v_and_b32 v235, 0xffff0000, v3
    v_cvt_pk_bf16_f32 v2, v232, v233
    v_lshlrev_b32 v232, 16, v2
    v_and_b32 v233, 0xffff0000, v2
    v_cvt_pk_bf16_f32 v3, v236, v237
    v_lshlrev_b32 v236, 16, v3
    v_and_b32 v237, 0xffff0000, v3
    v_add_f32 v234, 0x3727c5ac, v234
    v_add_f32 v235, 0x3727c5ac, v235
    v_add_f32 v236, 0x3727c5ac, v236
    v_add_f32 v237, 0x3727c5ac, v237
    v_cvt_pk_bf16_f32 v2, v234, v235
    v_lshlrev_b32 v234, 16, v2
    v_and_b32 v235, 0xffff0000, v2
    ds_read_b64_tr_b16 v[216:217], v141 offset:16384
    ds_read_b64_tr_b16 v[218:219], v141 offset:17408
    s_waitcnt lgkmcnt(4)
    v_mfma_f32_32x32x16_bf16 v[164:179], v[88:91], v[224:227], v[164:179]
    v_cvt_pk_bf16_f32 v2, v236, v237
    v_lshlrev_b32 v236, 16, v2
    v_and_b32 v237, 0xffff0000, v2
    v_sqrt_f32 v234, v234
    v_sqrt_f32 v235, v235
    v_sqrt_f32 v236, v236
    v_sqrt_f32 v237, v237
    v_cvt_pk_bf16_f32 v2, v234, v235
    v_lshlrev_b32 v234, 16, v2
    v_and_b32 v235, 0xffff0000, v2
    v_cvt_pk_bf16_f32 v2, v236, v237
    v_lshlrev_b32 v236, 16, v2
    v_and_b32 v237, 0xffff0000, v2
    v_rcp_f32 v36, v234
    v_sub_f32 v230, 0, v230
    v_cvt_pk_bf16_f32 v20, v230, v230
    v_cvt_pk_bf16_f32 v21, v234, v234
    v_mov_b32 v22, 0
    ds_read_b64_tr_b16 v[220:221], v133 offset:24576
    ds_read_b64_tr_b16 v[222:223], v133 offset:25600
    s_waitcnt lgkmcnt(4)
    v_mfma_f32_32x32x16_bf16 v[164:179], v[92:95], v[212:215], v[164:179]
    v_mov_b32 v23, 0
    v_mul_f32 v44, v234, v234
    v_mul_f32 v40, v36, v36
    v_mul_f32 v40, v40, v36
    v_mul_f32 v40, 0xbdd2d3e8, v40
    v_mul_f32 v36, 0xc0135761, v36
    v_rcp_f32 v37, v235
    v_sub_f32 v231, 0, v231
    v_cvt_pk_bf16_f32 v24, v231, v231
    v_cvt_pk_bf16_f32 v25, v235, v235
    v_mov_b32 v26, 0
    v_mov_b32 v27, 0
    v_mul_f32 v45, v235, v235
    v_mul_f32 v41, v37, v37
    v_mul_f32 v41, v41, v37
    v_mul_f32 v41, 0xbdd2d3e8, v41
    v_mul_f32 v37, 0xc0135761, v37
    ds_read_b64_tr_b16 v[224:225], v141 offset:24576
    ds_read_b64_tr_b16 v[226:227], v141 offset:25600
    s_waitcnt lgkmcnt(4)
    v_mfma_f32_32x32x16_bf16 v[164:179], v[96:99], v[216:219], v[164:179]
    v_rcp_f32 v38, v236
    v_sub_f32 v232, 0, v232
    v_cvt_pk_bf16_f32 v28, v232, v232
    v_cvt_pk_bf16_f32 v29, v236, v236
    v_mov_b32 v30, 0
    v_mov_b32 v31, 0
    v_mul_f32 v46, v236, v236
    v_mul_f32 v42, v38, v38
    v_mul_f32 v42, v42, v38
    v_mul_f32 v42, 0xbdd2d3e8, v42
    v_mul_f32 v38, 0xc0135761, v38
    v_rcp_f32 v39, v237
    v_sub_f32 v233, 0, v233
    v_cvt_pk_bf16_f32 v32, v233, v233
    v_cvt_pk_bf16_f32 v33, v237, v237
    v_mov_b32 v34, 0
    v_mov_b32 v35, 0
    ds_read_b64_tr_b16 v[212:213], v133 offset:32768
    ds_read_b64_tr_b16 v[214:215], v133 offset:33792
    s_waitcnt lgkmcnt(4)
    v_mfma_f32_32x32x16_bf16 v[164:179], v[100:103], v[220:223], v[164:179]
    v_mul_f32 v47, v237, v237
    v_mul_f32 v43, v39, v39
    v_mul_f32 v43, v43, v39
    v_mul_f32 v43, 0xbdd2d3e8, v43
    v_mul_f32 v39, 0xc0135761, v39
    s_waitcnt vmcnt(0)
    v_cmp_gt_u32 vcc, 32, v1
    s_nop 1
    v_cndmask_b32 v12, 0, v12, vcc
    v_cndmask_b32 v13, 0, v13, vcc
    v_cvt_pk_bf16_f32 v2, v12, v13
    v_lshlrev_b32 v14, 16, v2
    v_and_b32 v15, 0xffff0000, v2
    v_sub_f32 v12, v12, v14
    v_sub_f32 v13, v13, v15
    v_cvt_pk_bf16_f32 v16, v14, v12
    v_cvt_pk_bf16_f32 v17, v15, v13
    v_mov_b32 v18, 0
    ds_read_b64_tr_b16 v[216:217], v141 offset:32768
    ds_read_b64_tr_b16 v[218:219], v141 offset:33792
    s_waitcnt lgkmcnt(4)
    v_mfma_f32_32x32x16_bf16 v[164:179], v[104:107], v[224:227], v[164:179]
    v_mov_b32 v19, 0
    s_nop 1
    v_mfma_f32_32x32x16_bf16 v[148:163], v[16:19], v[20:23], v[148:163]
    v_mfma_f32_32x32x16_bf16 v[164:179], v[16:19], v[24:27], v[164:179]
    v_mfma_f32_32x32x16_bf16 v[180:195], v[16:19], v[28:31], v[180:195]
    v_mfma_f32_32x32x16_bf16 v[196:211], v[16:19], v[32:35], v[196:211]
    s_nop 8
    v_mul_f32 v238, v148, v148
    v_mul_f32 v239, v149, v149
    v_mul_f32 v240, v150, v150
    v_mul_f32 v241, v151, v151
    v_fma_f32 v238, v238, v40, v36
    v_fma_f32 v239, v239, v40, v36
    v_fma_f32 v240, v240, v40, v36
    v_fma_f32 v241, v241, v40, v36
    v_mul_f32 v238, v238, v148
    v_mul_f32 v239, v239, v149
    v_mul_f32 v240, v240, v150
    v_mul_f32 v241, v241, v151
    ds_read_b64_tr_b16 v[220:221], v133 offset:40960
    ds_read_b64_tr_b16 v[222:223], v133 offset:41984
    s_waitcnt lgkmcnt(4)
    v_mfma_f32_32x32x16_bf16 v[164:179], v[108:111], v[212:215], v[164:179]
    v_exp_f32 v238, v238
    v_mul_f32 v230, v148, v156
    v_exp_f32 v239, v239
    v_mul_f32 v231, v149, v157
    v_exp_f32 v240, v240
    v_mul_f32 v232, v150, v158
    v_exp_f32 v241, v241
    v_mul_f32 v233, v151, v159
    v_fma_f32 v238, v238, v44, v44
    v_fma_f32 v239, v239, v44, v44
    v_fma_f32 v240, v240, v44, v44
    v_fma_f32 v241, v241, v44, v44
    v_rcp_f32 v238, v238
    v_rcp_f32 v239, v239
    v_rcp_f32 v240, v240
    v_rcp_f32 v241, v241
    v_mul_f32 v230, v230, v238
    ds_read_b64_tr_b16 v[224:225], v141 offset:40960
    ds_read_b64_tr_b16 v[226:227], v141 offset:41984
    s_waitcnt lgkmcnt(4)
    v_mfma_f32_32x32x16_bf16 v[164:179], v[112:115], v[216:219], v[164:179]
    v_mul_f32 v231, v231, v239
    v_mul_f32 v232, v232, v240
    v_mul_f32 v233, v233, v241
    v_cvt_pk_bf16_f32 v52, v230, v231
    v_cvt_pk_bf16_f32 v53, v232, v233
    v_mul_f32 v238, v152, v152
    v_mul_f32 v239, v153, v153
    v_mul_f32 v240, v154, v154
    v_mul_f32 v241, v155, v155
    v_fma_f32 v238, v238, v40, v36
    v_fma_f32 v239, v239, v40, v36
    v_fma_f32 v240, v240, v40, v36
    v_fma_f32 v241, v241, v40, v36
    v_mul_f32 v238, v238, v152
    v_mul_f32 v239, v239, v153
    v_mul_f32 v240, v240, v154
    v_mul_f32 v241, v241, v155
    ds_read_b64_tr_b16 v[212:213], v130 offset:49152
    ds_read_b64_tr_b16 v[214:215], v130 offset:50176
    s_waitcnt lgkmcnt(4)
    v_mfma_f32_32x32x16_bf16 v[164:179], v[116:119], v[220:223], v[164:179]
    v_exp_f32 v238, v238
    v_mul_f32 v230, v152, v160
    v_exp_f32 v239, v239
    v_mul_f32 v231, v153, v161
    v_exp_f32 v240, v240
    v_mul_f32 v232, v154, v162
    v_exp_f32 v241, v241
    v_mul_f32 v233, v155, v163
    v_fma_f32 v238, v238, v44, v44
    v_fma_f32 v239, v239, v44, v44
    v_fma_f32 v240, v240, v44, v44
    v_fma_f32 v241, v241, v44, v44
    v_rcp_f32 v238, v238
    v_rcp_f32 v239, v239
    v_rcp_f32 v240, v240
    v_rcp_f32 v241, v241
    v_mul_f32 v230, v230, v238
    ds_read_b64_tr_b16 v[216:217], v138 offset:49152
    ds_read_b64_tr_b16 v[218:219], v138 offset:50176
    s_waitcnt lgkmcnt(4)
    v_mfma_f32_32x32x16_bf16 v[164:179], v[120:123], v[224:227], v[164:179]
    v_mul_f32 v231, v231, v239
    v_mul_f32 v232, v232, v240
    v_mul_f32 v233, v233, v241
    v_cvt_pk_bf16_f32 v54, v230, v231
    v_cvt_pk_bf16_f32 v55, v232, v233
    s_add_u32 s48, s3, 0
    s_and_b32 s48, s48, 3
    s_lshl_b32 s49, s46, 2
    s_add_u32 s48, s48, s49
    s_mul_i32 s48, s48, 112
    s_add_u32 s48, s48, s47
    s_lshl_b32 s48, s48, 10
    buffer_store_dwordx4 v[52:55], v5, s[32:35], s48 offen sc1
    buffer_load_dwordx4 v[148:151], v5, s[36:39], s62 offen offset:0
    buffer_load_dwordx4 v[152:155], v5, s[36:39], s63 offen offset:0
    buffer_load_dwordx4 v[156:159], v5, s[36:39], s62 offen offset:1024
    buffer_load_dwordx4 v[160:163], v5, s[36:39], s63 offen offset:1024
    ds_read_b64_tr_b16 v[220:221], v130 offset:57344
    ds_read_b64_tr_b16 v[222:223], v130 offset:58368
    s_waitcnt lgkmcnt(4)
    v_mfma_f32_32x32x16_bf16 v[180:195], v[60:63], v[212:215], v[180:195]
    ds_read_b64_tr_b16 v[224:225], v138 offset:57344
    ds_read_b64_tr_b16 v[226:227], v138 offset:58368
    s_waitcnt lgkmcnt(4)
    v_mfma_f32_32x32x16_bf16 v[180:195], v[64:67], v[216:219], v[180:195]
    v_mul_f32 v238, v164, v164
    v_mul_f32 v239, v165, v165
    v_mul_f32 v240, v166, v166
    v_mul_f32 v241, v167, v167
    v_fma_f32 v238, v238, v41, v37
    v_fma_f32 v239, v239, v41, v37
    ds_read_b64_tr_b16 v[212:213], v134 offset:0
    ds_read_b64_tr_b16 v[214:215], v134 offset:1024
    s_waitcnt lgkmcnt(4)
    v_mfma_f32_32x32x16_bf16 v[180:195], v[68:71], v[220:223], v[180:195]
    v_fma_f32 v240, v240, v41, v37
    v_fma_f32 v241, v241, v41, v37
    v_mul_f32 v238, v238, v164
    v_mul_f32 v239, v239, v165
    v_mul_f32 v240, v240, v166
    v_mul_f32 v241, v241, v167
    ds_read_b64_tr_b16 v[216:217], v142 offset:0
    ds_read_b64_tr_b16 v[218:219], v142 offset:1024
    s_waitcnt lgkmcnt(4)
    v_mfma_f32_32x32x16_bf16 v[180:195], v[72:75], v[224:227], v[180:195]
    v_exp_f32 v238, v238
    v_mul_f32 v230, v164, v172
    v_exp_f32 v239, v239
    v_mul_f32 v231, v165, v173
    v_exp_f32 v240, v240
    v_mul_f32 v232, v166, v174
    ds_read_b64_tr_b16 v[220:221], v134 offset:8192
    ds_read_b64_tr_b16 v[222:223], v134 offset:9216
    s_waitcnt lgkmcnt(4)
    v_mfma_f32_32x32x16_bf16 v[180:195], v[76:79], v[212:215], v[180:195]
    v_exp_f32 v241, v241
    v_mul_f32 v233, v167, v175
    v_fma_f32 v238, v238, v45, v45
    v_fma_f32 v239, v239, v45, v45
    v_fma_f32 v240, v240, v45, v45
    v_fma_f32 v241, v241, v45, v45
    ds_read_b64_tr_b16 v[224:225], v142 offset:8192
    ds_read_b64_tr_b16 v[226:227], v142 offset:9216
    s_waitcnt lgkmcnt(4)
    v_mfma_f32_32x32x16_bf16 v[180:195], v[80:83], v[216:219], v[180:195]
    v_rcp_f32 v238, v238
    v_rcp_f32 v239, v239
    v_rcp_f32 v240, v240
    v_rcp_f32 v241, v241
    v_mul_f32 v230, v230, v238
    v_mul_f32 v231, v231, v239
    ds_read_b64_tr_b16 v[212:213], v134 offset:16384
    ds_read_b64_tr_b16 v[214:215], v134 offset:17408
    s_waitcnt lgkmcnt(4)
    v_mfma_f32_32x32x16_bf16 v[180:195], v[84:87], v[220:223], v[180:195]
    v_mul_f32 v232, v232, v240
    v_mul_f32 v233, v233, v241
    v_cvt_pk_bf16_f32 v56, v230, v231
    v_cvt_pk_bf16_f32 v57, v232, v233
    v_mul_f32 v238, v168, v168
    v_mul_f32 v239, v169, v169
    ds_read_b64_tr_b16 v[216:217], v142 offset:16384
    ds_read_b64_tr_b16 v[218:219], v142 offset:17408
    s_waitcnt lgkmcnt(4)
    v_mfma_f32_32x32x16_bf16 v[180:195], v[88:91], v[224:227], v[180:195]
    v_mul_f32 v240, v170, v170
    v_mul_f32 v241, v171, v171
    v_fma_f32 v238, v238, v41, v37
    v_fma_f32 v239, v239, v41, v37
    v_fma_f32 v240, v240, v41, v37
    v_fma_f32 v241, v241, v41, v37
    ds_read_b64_tr_b16 v[220:221], v134 offset:24576
    ds_read_b64_tr_b16 v[222:223], v134 offset:25600
    s_waitcnt lgkmcnt(4)
    v_mfma_f32_32x32x16_bf16 v[180:195], v[92:95], v[212:215], v[180:195]
    v_mul_f32 v238, v238, v168
    v_mul_f32 v239, v239, v169
    v_mul_f32 v240, v240, v170
    v_mul_f32 v241, v241, v171
    v_exp_f32 v238, v238
    ds_read_b64_tr_b16 v[224:225], v142 offset:24576
    ds_read_b64_tr_b16 v[226:227], v142 offset:25600
    s_waitcnt lgkmcnt(4)
    v_mfma_f32_32x32x16_bf16 v[180:195], v[96:99], v[216:219], v[180:195]
    v_mul_f32 v230, v168, v176
    v_exp_f32 v239, v239
    v_mul_f32 v231, v169, v177
    v_exp_f32 v240, v240
    v_mul_f32 v232, v170, v178
    ds_read_b64_tr_b16 v[212:213], v134 offset:32768
    ds_read_b64_tr_b16 v[214:215], v134 offset:33792
    s_waitcnt lgkmcnt(4)
    v_mfma_f32_32x32x16_bf16 v[180:195], v[100:103], v[220:223], v[180:195]
    v_exp_f32 v241, v241
    v_mul_f32 v233, v171, v179
    v_fma_f32 v238, v238, v45, v45
    v_fma_f32 v239, v239, v45, v45
    v_fma_f32 v240, v240, v45, v45
    ds_read_b64_tr_b16 v[216:217], v142 offset:32768
    ds_read_b64_tr_b16 v[218:219], v142 offset:33792
    s_waitcnt lgkmcnt(4)
    v_mfma_f32_32x32x16_bf16 v[180:195], v[104:107], v[224:227], v[180:195]
    v_fma_f32 v241, v241, v45, v45
    v_rcp_f32 v238, v238
    v_rcp_f32 v239, v239
    v_rcp_f32 v240, v240
    v_rcp_f32 v241, v241
    ds_read_b64_tr_b16 v[220:221], v134 offset:40960
    ds_read_b64_tr_b16 v[222:223], v134 offset:41984
    s_waitcnt lgkmcnt(4)
    v_mfma_f32_32x32x16_bf16 v[180:195], v[108:111], v[212:215], v[180:195]
    v_mul_f32 v230, v230, v238
    v_mul_f32 v231, v231, v239
    v_mul_f32 v232, v232, v240
    v_mul_f32 v233, v233, v241
    v_cvt_pk_bf16_f32 v58, v230, v231
    ds_read_b64_tr_b16 v[224:225], v142 offset:40960
    ds_read_b64_tr_b16 v[226:227], v142 offset:41984
    s_waitcnt lgkmcnt(4)
    v_mfma_f32_32x32x16_bf16 v[180:195], v[112:115], v[216:219], v[180:195]
    v_cvt_pk_bf16_f32 v59, v232, v233
    s_add_u32 s48, s3, 1
    s_and_b32 s48, s48, 3
    s_lshl_b32 s49, s46, 2
    s_add_u32 s48, s48, s49
    ds_read_b64_tr_b16 v[212:213], v131 offset:49152
    ds_read_b64_tr_b16 v[214:215], v131 offset:50176
    s_waitcnt lgkmcnt(4)
    v_mfma_f32_32x32x16_bf16 v[180:195], v[116:119], v[220:223], v[180:195]
    s_mul_i32 s48, s48, 112
    s_add_u32 s48, s48, s47
    s_lshl_b32 s48, s48, 10
    buffer_store_dwordx4 v[56:59], v5, s[32:35], s48 offen sc1
    buffer_load_dwordx4 v[164:167], v5, s[36:39], s62 offen offset:2048
    ds_read_b64_tr_b16 v[216:217], v139 offset:49152
    ds_read_b64_tr_b16 v[218:219], v139 offset:50176
    s_waitcnt lgkmcnt(4)
    v_mfma_f32_32x32x16_bf16 v[180:195], v[120:123], v[224:227], v[180:195]
    buffer_load_dwordx4 v[168:171], v5, s[36:39], s63 offen offset:2048
    buffer_load_dwordx4 v[172:175], v5, s[36:39], s62 offen offset:3072
    buffer_load_dwordx4 v[176:179], v5, s[36:39], s63 offen offset:3072
    s_add_u32 s62, s62, 4096
    s_add_u32 s63, s63, 4096
    ds_read_b64_tr_b16 v[220:221], v131 offset:57344
    ds_read_b64_tr_b16 v[222:223], v131 offset:58368
    s_waitcnt lgkmcnt(4)
    v_mfma_f32_32x32x16_bf16 v[196:211], v[60:63], v[212:215], v[196:211]
    ds_read_b64_tr_b16 v[224:225], v139 offset:57344
    ds_read_b64_tr_b16 v[226:227], v139 offset:58368
    s_waitcnt lgkmcnt(4)
    v_mfma_f32_32x32x16_bf16 v[196:211], v[64:67], v[216:219], v[196:211]
    v_mul_f32 v238, v180, v180
    v_mul_f32 v239, v181, v181
    v_mul_f32 v240, v182, v182
    v_mul_f32 v241, v183, v183
    v_fma_f32 v238, v238, v42, v38
    v_fma_f32 v239, v239, v42, v38
    ds_read_b64_tr_b16 v[212:213], v135 offset:0
    ds_read_b64_tr_b16 v[214:215], v135 offset:1024
    s_waitcnt lgkmcnt(4)
    v_mfma_f32_32x32x16_bf16 v[196:211], v[68:71], v[220:223], v[196:211]
    v_fma_f32 v240, v240, v42, v38
    v_fma_f32 v241, v241, v42, v38
    v_mul_f32 v238, v238, v180
    v_mul_f32 v239, v239, v181
    v_mul_f32 v240, v240, v182
    v_mul_f32 v241, v241, v183
    ds_read_b64_tr_b16 v[216:217], v143 offset:0
    ds_read_b64_tr_b16 v[218:219], v143 offset:1024
    s_waitcnt lgkmcnt(4)
    v_mfma_f32_32x32x16_bf16 v[196:211], v[72:75], v[224:227], v[196:211]
    v_exp_f32 v238, v238
    v_mul_f32 v230, v180, v188
    v_exp_f32 v239, v239
    v_mul_f32 v231, v181, v189
    v_exp_f32 v240, v240
    v_mul_f32 v232, v182, v190
    ds_read_b64_tr_b16 v[220:221], v135 offset:8192
    ds_read_b64_tr_b16 v[222:223], v135 offset:9216
    s_waitcnt lgkmcnt(4)
    v_mfma_f32_32x32x16_bf16 v[196:211], v[76:79], v[212:215], v[196:211]
    v_exp_f32 v241, v241
    v_mul_f32 v233, v183, v191
    v_fma_f32 v238, v238, v46, v46
    v_fma_f32 v239, v239, v46, v46
    v_fma_f32 v240, v240, v46, v46
    v_fma_f32 v241, v241, v46, v46
    buffer_load_dwordx4 v[76:79], v5, s[36:39], s56 offen offset:0
    ds_read_b64_tr_b16 v[224:225], v143 offset:8192
    ds_read_b64_tr_b16 v[226:227], v143 offset:9216
    s_waitcnt lgkmcnt(4)
    v_mfma_f32_32x32x16_bf16 v[196:211], v[80:83], v[216:219], v[196:211]
    v_rcp_f32 v238, v238
    v_rcp_f32 v239, v239
    v_rcp_f32 v240, v240
    v_rcp_f32 v241, v241
    v_mul_f32 v230, v230, v238
    v_mul_f32 v231, v231, v239
    buffer_load_dwordx4 v[80:83], v5, s[36:39], s57 offen offset:0
    ds_read_b64_tr_b16 v[212:213], v135 offset:16384
    ds_read_b64_tr_b16 v[214:215], v135 offset:17408
    s_waitcnt lgkmcnt(4)
    v_mfma_f32_32x32x16_bf16 v[196:211], v[84:87], v[220:223], v[196:211]
    v_mul_f32 v232, v232, v240
    v_mul_f32 v233, v233, v241
    v_cvt_pk_bf16_f32 v52, v230, v231
    v_cvt_pk_bf16_f32 v53, v232, v233
    v_mul_f32 v238, v184, v184
    buffer_load_dwordx4 v[84:87], v5, s[36:39], s56 offen offset:1024
    ds_read_b64_tr_b16 v[216:217], v143 offset:16384
    ds_read_b64_tr_b16 v[218:219], v143 offset:17408
    s_waitcnt lgkmcnt(4)
    v_mfma_f32_32x32x16_bf16 v[196:211], v[88:91], v[224:227], v[196:211]
    v_mul_f32 v239, v185, v185
    v_mul_f32 v240, v186, v186
    v_mul_f32 v241, v187, v187
    v_fma_f32 v238, v238, v42, v38
    v_fma_f32 v239, v239, v42, v38
    buffer_load_dwordx4 v[88:91], v5, s[36:39], s57 offen offset:1024
    ds_read_b64_tr_b16 v[220:221], v135 offset:24576
    ds_read_b64_tr_b16 v[222:223], v135 offset:25600
    s_waitcnt lgkmcnt(4)
    v_mfma_f32_32x32x16_bf16 v[196:211], v[92:95], v[212:215], v[196:211]
    v_fma_f32 v240, v240, v42, v38
    v_fma_f32 v241, v241, v42, v38
    v_mul_f32 v238, v238, v184
    v_mul_f32 v239, v239, v185
    v_mul_f32 v240, v240, v186
    buffer_load_dwordx4 v[92:95], v5, s[36:39], s56 offen offset:2048
    ds_read_b64_tr_b16 v[224:225], v143 offset:24576
    ds_read_b64_tr_b16 v[226:227], v143 offset:25600
    s_waitcnt lgkmcnt(4)
    v_mfma_f32_32x32x16_bf16 v[196:211], v[96:99], v[216:219], v[196:211]
    v_mul_f32 v241, v241, v187
    v_exp_f32 v238, v238
    v_mul_f32 v230, v184, v192
    v_exp_f32 v239, v239
    v_mul_f32 v231, v185, v193
    buffer_load_dwordx4 v[96:99], v5, s[36:39], s57 offen offset:2048
    ds_read_b64_tr_b16 v[212:213], v135 offset:32768
    ds_read_b64_tr_b16 v[214:215], v135 offset:33792
    s_waitcnt lgkmcnt(4)
    v_mfma_f32_32x32x16_bf16 v[196:211], v[100:103], v[220:223], v[196:211]
    v_exp_f32 v240, v240
    v_mul_f32 v232, v186, v194
    v_exp_f32 v241, v241
    v_mul_f32 v233, v187, v195
    v_fma_f32 v238, v238, v46, v46
    buffer_load_dwordx4 v[100:103], v5, s[36:39], s56 offen offset:3072
    ds_read_b64_tr_b16 v[216:217], v143 offset:32768
    ds_read_b64_tr_b16 v[218:219], v143 offset:33792
    s_waitcnt lgkmcnt(4)
    v_mfma_f32_32x32x16_bf16 v[196:211], v[104:107], v[224:227], v[196:211]
    v_fma_f32 v239, v239, v46, v46
    v_fma_f32 v240, v240, v46, v46
    v_fma_f32 v241, v241, v46, v46
    v_rcp_f32 v238, v238
    v_rcp_f32 v239, v239
    buffer_load_dwordx4 v[104:107], v5, s[36:39], s57 offen offset:3072
    ds_read_b64_tr_b16 v[220:221], v135 offset:40960
    ds_read_b64_tr_b16 v[222:223], v135 offset:41984
    s_waitcnt lgkmcnt(4)
    v_mfma_f32_32x32x16_bf16 v[196:211], v[108:111], v[212:215], v[196:211]
    v_rcp_f32 v240, v240
    v_rcp_f32 v241, v241
    v_mul_f32 v230, v230, v238
    v_mul_f32 v231, v231, v239
    v_mul_f32 v232, v232, v240
    buffer_load_dwordx4 v[108:111], v5, s[36:39], s58 offen offset:0
    ds_read_b64_tr_b16 v[224:225], v143 offset:40960
    ds_read_b64_tr_b16 v[226:227], v143 offset:41984
    s_waitcnt lgkmcnt(4)
    v_mfma_f32_32x32x16_bf16 v[196:211], v[112:115], v[216:219], v[196:211]
    v_mul_f32 v233, v233, v241
    v_cvt_pk_bf16_f32 v54, v230, v231
    v_cvt_pk_bf16_f32 v55, v232, v233
    s_add_u32 s48, s3, 2
    s_and_b32 s48, s48, 3
    buffer_load_dwordx4 v[112:115], v5, s[36:39], s59 offen offset:0
    s_waitcnt lgkmcnt(2)
    v_mfma_f32_32x32x16_bf16 v[196:211], v[116:119], v[220:223], v[196:211]
    s_lshl_b32 s49, s46, 2
    s_add_u32 s48, s48, s49
    s_mul_i32 s48, s48, 112
    s_add_u32 s48, s48, s47
    s_lshl_b32 s48, s48, 10
    buffer_load_dwordx4 v[116:119], v5, s[36:39], s58 offen offset:1024
    s_waitcnt lgkmcnt(0)
    v_mfma_f32_32x32x16_bf16 v[196:211], v[120:123], v[224:227], v[196:211]
    buffer_store_dwordx4 v[52:55], v5, s[32:35], s48 offen sc1
    buffer_load_dwordx4 v[180:183], v5, s[36:39], s62 offen offset:0
    buffer_load_dwordx4 v[184:187], v5, s[36:39], s63 offen offset:0
    buffer_load_dwordx4 v[188:191], v5, s[36:39], s62 offen offset:1024
    buffer_load_dwordx4 v[192:195], v5, s[36:39], s63 offen offset:1024
    buffer_load_dwordx4 v[120:123], v5, s[36:39], s59 offen offset:1024
    s_nop 5
    v_mul_f32 v238, v196, v196
    v_mul_f32 v239, v197, v197
    v_mul_f32 v240, v198, v198
    v_mul_f32 v241, v199, v199
    v_fma_f32 v238, v238, v43, v39
    v_fma_f32 v239, v239, v43, v39
    v_fma_f32 v240, v240, v43, v39
    v_fma_f32 v241, v241, v43, v39
    v_mul_f32 v238, v238, v196
    v_mul_f32 v239, v239, v197
    v_mul_f32 v240, v240, v198
    v_mul_f32 v241, v241, v199
    v_exp_f32 v238, v238
    v_mul_f32 v230, v196, v204
    v_exp_f32 v239, v239
    v_mul_f32 v231, v197, v205
    v_exp_f32 v240, v240
    v_mul_f32 v232, v198, v206
    v_exp_f32 v241, v241
    v_mul_f32 v233, v199, v207
    v_fma_f32 v238, v238, v47, v47
    v_fma_f32 v239, v239, v47, v47
    v_fma_f32 v240, v240, v47, v47
    v_fma_f32 v241, v241, v47, v47
    v_rcp_f32 v238, v238
    v_rcp_f32 v239, v239
    v_rcp_f32 v240, v240
    v_rcp_f32 v241, v241
    v_mul_f32 v230, v230, v238
    v_mul_f32 v231, v231, v239
    v_mul_f32 v232, v232, v240
    v_mul_f32 v233, v233, v241
    v_cvt_pk_bf16_f32 v56, v230, v231
    v_cvt_pk_bf16_f32 v57, v232, v233
    v_mul_f32 v238, v200, v200
    v_mul_f32 v239, v201, v201
    v_mul_f32 v240, v202, v202
    v_mul_f32 v241, v203, v203
    v_fma_f32 v238, v238, v43, v39
    v_fma_f32 v239, v239, v43, v39
    v_fma_f32 v240, v240, v43, v39
    v_fma_f32 v241, v241, v43, v39
    v_mul_f32 v238, v238, v200
    v_mul_f32 v239, v239, v201
    v_mul_f32 v240, v240, v202
    v_mul_f32 v241, v241, v203
    v_exp_f32 v238, v238
    v_mul_f32 v230, v200, v208
    v_exp_f32 v239, v239
    v_mul_f32 v231, v201, v209
    v_exp_f32 v240, v240
    v_mul_f32 v232, v202, v210
    v_exp_f32 v241, v241
    v_mul_f32 v233, v203, v211
    v_fma_f32 v238, v238, v47, v47
    v_fma_f32 v239, v239, v47, v47
    v_fma_f32 v240, v240, v47, v47
    v_fma_f32 v241, v241, v47, v47
    v_rcp_f32 v238, v238
    v_rcp_f32 v239, v239
    v_rcp_f32 v240, v240
    v_rcp_f32 v241, v241
    v_mul_f32 v230, v230, v238
    v_mul_f32 v231, v231, v239
    v_mul_f32 v232, v232, v240
    v_mul_f32 v233, v233, v241
    v_cvt_pk_bf16_f32 v58, v230, v231
    v_cvt_pk_bf16_f32 v59, v232, v233
    s_add_u32 s48, s3, 3
    s_and_b32 s48, s48, 3
    s_lshl_b32 s49, s46, 2
    s_add_u32 s48, s48, s49
    s_mul_i32 s48, s48, 112
    s_add_u32 s48, s48, s47
    s_lshl_b32 s48, s48, 10
    buffer_store_dwordx4 v[56:59], v5, s[32:35], s48 offen sc1
    buffer_load_dwordx4 v[196:199], v5, s[36:39], s62 offen offset:2048
    buffer_load_dwordx4 v[200:203], v5, s[36:39], s63 offen offset:2048
    buffer_load_dwordx4 v[204:207], v5, s[36:39], s62 offen offset:3072
    buffer_load_dwordx4 v[208:211], v5, s[36:39], s63 offen offset:3072
    s_add_u32 s62, s62, 4096
    s_add_u32 s63, s63, 4096
    s_lshl_b32 s47, s46, 7
    s_add_u32 s47, s47, 2048
    s_waitcnt vmcnt(4) lgkmcnt(0)
    s_barrier
    s_cmp_lg_u32 s3, 0
    s_cbranch_scc1 SIG_S3
    s_mov_b64 exec, 1
    v_mov_b32 v8, 1
    v_mov_b32 v9, 0
    buffer_atomic_add v8, v9, s[40:43], s47 offen sc1
    s_mov_b64 exec, -1
SIG_S3:
    s_and_b32 s44, s69, 7
    s_lshr_b32 s45, s69, 3
    s_lshl_b32 s46, s44, 2
    s_and_b32 s47, s45, 3
    s_add_u32 s46, s46, s47
    s_lshr_b32 s47, s45, 2
    s_mov_b32 s28, s16
    s_mov_b32 s29, s17
    s_mov_b32 s30, 21504
    s_mov_b32 s31, 0x00020000
    s_mov_b32 s24, s14
    s_mov_b32 s25, s15
    s_mov_b32 s26, 1835008
    s_mov_b32 s27, 0x00020000
    s_mul_i32 s60, s3, 14
    s_mul_i32 s58, s46, 224
    s_add_u32 s58, s58, s60
    s_lshl_b32 s58, s58, 10
    s_add_u32 s59, s58, 114688
    s_lshr_b32 s48, s3, 2
    s_bfe_u32 s49, s3, 0x10001
    s_and_b32 s53, s3, 1
    s_lshl_b32 s52, s47, 1
    s_add_u32 s52, s52, s48
    s_lshl_b32 s54, s46, 1
    s_add_u32 s54, s54, s49
    v_lshlrev_b32 v4, 10, v6
    v_lshl_add_u32 v4, v7, 1, v4
    s_lshr_b32 s61, s54, 2
    s_mul_i32 s61, s61, 114688
    s_lshl_b32 s62, s52, 13
    s_add_u32 s61, s61, s62
    s_and_b32 s62, s54, 3
    s_lshl_b32 s62, s62, 6
    s_add_u32 s61, s61, s62
    s_lshl_b32 s62, s53, 12
    s_add_u32 s61, s61, s62
    buffer_load_ushort v128, v4, s[20:23], s61 offen offset:0
    buffer_load_ushort v129, v4, s[20:23], s61 offen offset:256
    buffer_load_ushort v130, v4, s[20:23], s61 offen offset:512
    buffer_load_ushort v131, v4, s[20:23], s61 offen offset:768
    buffer_load_ushort v132, v4, s[20:23], s61 offen offset:2048
    buffer_load_ushort v133, v4, s[20:23], s61 offen offset:2304
    buffer_load_ushort v134, v4, s[20:23], s61 offen offset:2560
    buffer_load_ushort v135, v4, s[20:23], s61 offen offset:2816
    v_lshlrev_b32 v2, 4, v6
    s_lshl_b32 s62, s52, 7
    s_lshl_b32 s63, s53, 6
    s_add_u32 s62, s62, s63
    s_add_u32 s62, s62, 8960
    s_mov_b32 s64, s62
    buffer_load_dwordx4 v[136:139], v2, s[28:31], s62 offen offset:0
    buffer_load_dwordx4 v[140:143], v2, s[28:31], s62 offen offset:32
    v_mov_b32 v12, 0
    v_mov_b32 v13, 0
    v_mov_b32 v14, 0
    v_mov_b32 v15, 0
    v_mov_b32 v16, 0
    v_mov_b32 v17, 0
    v_mov_b32 v18, 0
    v_mov_b32 v19, 0
    v_mov_b32 v20, 0
    v_mov_b32 v21, 0
    v_mov_b32 v22, 0
    v_mov_b32 v23, 0
    v_mov_b32 v24, 0
    v_mov_b32 v25, 0
    v_mov_b32 v26, 0
    v_mov_b32 v27, 0
    v_mov_b32 v28, 0
    v_mov_b32 v29, 0
    v_mov_b32 v30, 0
    v_mov_b32 v31, 0
    v_mov_b32 v32, 0
    v_mov_b32 v33, 0
    v_mov_b32 v34, 0
    v_mov_b32 v35, 0
    v_mov_b32 v36, 0
    v_mov_b32 v37, 0
    v_mov_b32 v38, 0
    v_mov_b32 v39, 0
    v_mov_b32 v40, 0
    v_mov_b32 v41, 0
    v_mov_b32 v42, 0
    v_mov_b32 v43, 0
    v_mov_b32 v44, 0
    v_mov_b32 v45, 0
    v_mov_b32 v46, 0
    v_mov_b32 v47, 0
    v_mov_b32 v48, 0
    v_mov_b32 v49, 0
    v_mov_b32 v50, 0
    v_mov_b32 v51, 0
    v_mov_b32 v52, 0
    v_mov_b32 v53, 0
    v_mov_b32 v54, 0
    v_mov_b32 v55, 0
    v_mov_b32 v56, 0
    v_mov_b32 v57, 0
    v_mov_b32 v58, 0
    v_mov_b32 v59, 0
    v_mov_b32 v60, 0
    v_mov_b32 v61, 0
    v_mov_b32 v62, 0
    v_mov_b32 v63, 0
    v_mov_b32 v64, 0
    v_mov_b32 v65, 0
    v_mov_b32 v66, 0
    v_mov_b32 v67, 0
    v_mov_b32 v68, 0
    v_mov_b32 v69, 0
    v_mov_b32 v70, 0
    v_mov_b32 v71, 0
    v_mov_b32 v72, 0
    v_mov_b32 v73, 0
    v_mov_b32 v74, 0
    v_mov_b32 v75, 0
    s_lshr_b32 s45, s46, 1
    s_lshl_b32 s45, s45, 7
    s_add_u32 s45, s45, 2048
    s_cmp_lg_u32 s3, 0
    s_cbranch_scc1 WDONE_W3
    s_mov_b64 exec, 1
    v_lshlrev_b32 v9, 7, v0
    s_mov_b32 s65, 0
WLOOP_W3:
    buffer_load_dword v8, v9, s[40:43], s45 offen sc1
    s_add_u32 s65, s65, 1
    s_waitcnt vmcnt(0)
    v_cmp_gt_u32 vcc, 14, v8
    s_cmp_ge_u32 s65, 0x40000
    s_cbranch_scc1 WOUT_W3
    s_cbranch_vccz WOUT_W3
    s_sleep 4
    s_branch WLOOP_W3
WOUT_W3:
    s_mov_b64 exec, -1
WDONE_W3:
    s_barrier
    buffer_load_dwordx4 v[212:215], v5, s[32:35], s58 offen offset:0
    buffer_load_dwordx4 v[216:219], v5, s[32:35], s59 offen offset:0
    buffer_load_dwordx4 v[220:223], v5, s[32:35], s58 offen offset:1024
    buffer_load_dwordx4 v[224:227], v5, s[32:35], s59 offen offset:1024
    buffer_load_dwordx4 v[228:231], v5, s[32:35], s58 offen offset:2048
    buffer_load_dwordx4 v[232:235], v5, s[32:35], s59 offen offset:2048
    buffer_load_dwordx4 v[236:239], v5, s[32:35], s58 offen offset:3072
    buffer_load_dwordx4 v[240:243], v5, s[32:35], s59 offen offset:3072
    s_add_u32 s58, s58, 4096
    s_add_u32 s59, s59, 4096
    s_waitcnt vmcnt(6)
    v_mfma_f32_32x32x16_bf16 v[12:27], v[148:151], v[212:215], v[12:27]
    v_mfma_f32_32x32x16_bf16 v[28:43], v[148:151], v[216:219], v[28:43]
    v_mfma_f32_32x32x16_bf16 v[44:59], v[152:155], v[212:215], v[44:59]
    v_mfma_f32_32x32x16_bf16 v[60:75], v[152:155], v[216:219], v[60:75]
    buffer_load_dwordx4 v[212:215], v5, s[32:35], s58 offen offset:0
    buffer_load_dwordx4 v[216:219], v5, s[32:35], s59 offen offset:0
    s_waitcnt vmcnt(6)
    v_mfma_f32_32x32x16_bf16 v[12:27], v[156:159], v[220:223], v[12:27]
    v_mfma_f32_32x32x16_bf16 v[28:43], v[156:159], v[224:227], v[28:43]
    v_mfma_f32_32x32x16_bf16 v[44:59], v[160:163], v[220:223], v[44:59]
    v_mfma_f32_32x32x16_bf16 v[60:75], v[160:163], v[224:227], v[60:75]
    buffer_load_dwordx4 v[220:223], v5, s[32:35], s58 offen offset:1024
    buffer_load_dwordx4 v[224:227], v5, s[32:35], s59 offen offset:1024
    s_waitcnt vmcnt(6)
    v_mfma_f32_32x32x16_bf16 v[12:27], v[164:167], v[228:231], v[12:27]
    v_mfma_f32_32x32x16_bf16 v[28:43], v[164:167], v[232:235], v[28:43]
    v_mfma_f32_32x32x16_bf16 v[44:59], v[168:171], v[228:231], v[44:59]
    v_mfma_f32_32x32x16_bf16 v[60:75], v[168:171], v[232:235], v[60:75]
    buffer_load_dwordx4 v[228:231], v5, s[32:35], s58 offen offset:2048
    buffer_load_dwordx4 v[232:235], v5, s[32:35], s59 offen offset:2048
    s_waitcnt vmcnt(6)
    v_mfma_f32_32x32x16_bf16 v[12:27], v[172:175], v[236:239], v[12:27]
    v_mfma_f32_32x32x16_bf16 v[28:43], v[172:175], v[240:243], v[28:43]
    v_mfma_f32_32x32x16_bf16 v[44:59], v[176:179], v[236:239], v[44:59]
    v_mfma_f32_32x32x16_bf16 v[60:75], v[176:179], v[240:243], v[60:75]
    buffer_load_dwordx4 v[236:239], v5, s[32:35], s58 offen offset:3072
    buffer_load_dwordx4 v[240:243], v5, s[32:35], s59 offen offset:3072
    s_add_u32 s58, s58, 4096
    s_add_u32 s59, s59, 4096
    s_waitcnt vmcnt(6)
    v_mfma_f32_32x32x16_bf16 v[12:27], v[180:183], v[212:215], v[12:27]
    v_mfma_f32_32x32x16_bf16 v[28:43], v[180:183], v[216:219], v[28:43]
    v_mfma_f32_32x32x16_bf16 v[44:59], v[184:187], v[212:215], v[44:59]
    v_mfma_f32_32x32x16_bf16 v[60:75], v[184:187], v[216:219], v[60:75]
    buffer_load_dwordx4 v[212:215], v5, s[32:35], s58 offen offset:0
    buffer_load_dwordx4 v[216:219], v5, s[32:35], s59 offen offset:0
    s_waitcnt vmcnt(6)
    v_mfma_f32_32x32x16_bf16 v[12:27], v[188:191], v[220:223], v[12:27]
    v_mfma_f32_32x32x16_bf16 v[28:43], v[188:191], v[224:227], v[28:43]
    v_mfma_f32_32x32x16_bf16 v[44:59], v[192:195], v[220:223], v[44:59]
    v_mfma_f32_32x32x16_bf16 v[60:75], v[192:195], v[224:227], v[60:75]
    buffer_load_dwordx4 v[220:223], v5, s[32:35], s58 offen offset:1024
    buffer_load_dwordx4 v[224:227], v5, s[32:35], s59 offen offset:1024
    s_waitcnt vmcnt(6)
    v_mfma_f32_32x32x16_bf16 v[12:27], v[196:199], v[228:231], v[12:27]
    v_mfma_f32_32x32x16_bf16 v[28:43], v[196:199], v[232:235], v[28:43]
    v_mfma_f32_32x32x16_bf16 v[44:59], v[200:203], v[228:231], v[44:59]
    v_mfma_f32_32x32x16_bf16 v[60:75], v[200:203], v[232:235], v[60:75]
    buffer_load_dwordx4 v[228:231], v5, s[32:35], s58 offen offset:2048
    buffer_load_dwordx4 v[232:235], v5, s[32:35], s59 offen offset:2048
    s_waitcnt vmcnt(6)
    v_mfma_f32_32x32x16_bf16 v[12:27], v[204:207], v[236:239], v[12:27]
    v_mfma_f32_32x32x16_bf16 v[28:43], v[204:207], v[240:243], v[28:43]
    v_mfma_f32_32x32x16_bf16 v[44:59], v[208:211], v[236:239], v[44:59]
    v_mfma_f32_32x32x16_bf16 v[60:75], v[208:211], v[240:243], v[60:75]
    buffer_load_dwordx4 v[236:239], v5, s[32:35], s58 offen offset:3072
    buffer_load_dwordx4 v[240:243], v5, s[32:35], s59 offen offset:3072
    s_add_u32 s58, s58, 4096
    s_add_u32 s59, s59, 4096
    s_waitcnt vmcnt(6)
    v_mfma_f32_32x32x16_bf16 v[12:27], v[76:79], v[212:215], v[12:27]
    v_mfma_f32_32x32x16_bf16 v[28:43], v[76:79], v[216:219], v[28:43]
    v_mfma_f32_32x32x16_bf16 v[44:59], v[80:83], v[212:215], v[44:59]
    v_mfma_f32_32x32x16_bf16 v[60:75], v[80:83], v[216:219], v[60:75]
    buffer_load_dwordx4 v[212:215], v5, s[32:35], s58 offen offset:0
    buffer_load_dwordx4 v[216:219], v5, s[32:35], s59 offen offset:0
    s_waitcnt vmcnt(6)
    v_mfma_f32_32x32x16_bf16 v[12:27], v[84:87], v[220:223], v[12:27]
    v_mfma_f32_32x32x16_bf16 v[28:43], v[84:87], v[224:227], v[28:43]
    v_mfma_f32_32x32x16_bf16 v[44:59], v[88:91], v[220:223], v[44:59]
    v_mfma_f32_32x32x16_bf16 v[60:75], v[88:91], v[224:227], v[60:75]
    buffer_load_dwordx4 v[220:223], v5, s[32:35], s58 offen offset:1024
    buffer_load_dwordx4 v[224:227], v5, s[32:35], s59 offen offset:1024
    s_waitcnt vmcnt(6)
    v_mfma_f32_32x32x16_bf16 v[12:27], v[92:95], v[228:231], v[12:27]
    v_mfma_f32_32x32x16_bf16 v[28:43], v[92:95], v[232:235], v[28:43]
    v_mfma_f32_32x32x16_bf16 v[44:59], v[96:99], v[228:231], v[44:59]
    v_mfma_f32_32x32x16_bf16 v[60:75], v[96:99], v[232:235], v[60:75]
    s_waitcnt vmcnt(4)
    v_mfma_f32_32x32x16_bf16 v[12:27], v[100:103], v[236:239], v[12:27]
    v_mfma_f32_32x32x16_bf16 v[28:43], v[100:103], v[240:243], v[28:43]
    v_mfma_f32_32x32x16_bf16 v[44:59], v[104:107], v[236:239], v[44:59]
    v_mfma_f32_32x32x16_bf16 v[60:75], v[104:107], v[240:243], v[60:75]
    s_waitcnt vmcnt(2)
    v_mfma_f32_32x32x16_bf16 v[12:27], v[108:111], v[212:215], v[12:27]
    v_mfma_f32_32x32x16_bf16 v[28:43], v[108:111], v[216:219], v[28:43]
    v_mfma_f32_32x32x16_bf16 v[44:59], v[112:115], v[212:215], v[44:59]
    v_mfma_f32_32x32x16_bf16 v[60:75], v[112:115], v[216:219], v[60:75]
    s_waitcnt vmcnt(0)
    v_mfma_f32_32x32x16_bf16 v[12:27], v[116:119], v[220:223], v[12:27]
    v_mfma_f32_32x32x16_bf16 v[28:43], v[116:119], v[224:227], v[28:43]
    v_mfma_f32_32x32x16_bf16 v[44:59], v[120:123], v[220:223], v[44:59]
    v_mfma_f32_32x32x16_bf16 v[60:75], v[120:123], v[224:227], v[60:75]
    v_lshlrev_b32 v3, 4, v6
    s_add_u32 s62, s64, 10752
    buffer_load_dwordx4 v[220:223], v3, s[28:31], s62 offen offset:0
    buffer_load_dwordx4 v[224:227], v3, s[28:31], s62 offen offset:32
    s_lshl_b32 s62, s3, 14
    v_add_u32 v2, s62, v5
    s_nop 2
    ds_write_b128 v2, v[12:15] offset:0
    ds_write_b128 v2, v[16:19] offset:1024
    ds_write_b128 v2, v[20:23] offset:2048
    ds_write_b128 v2, v[24:27] offset:3072
    ds_write_b128 v2, v[28:31] offset:4096
    ds_write_b128 v2, v[32:35] offset:5120
    ds_write_b128 v2, v[36:39] offset:6144
    ds_write_b128 v2, v[40:43] offset:7168
    ds_write_b128 v2, v[44:47] offset:8192
    ds_write_b128 v2, v[48:51] offset:9216
    ds_write_b128 v2, v[52:55] offset:10240
    ds_write_b128 v2, v[56:59] offset:11264
    ds_write_b128 v2, v[60:63] offset:12288
    ds_write_b128 v2, v[64:67] offset:13312
    ds_write_b128 v2, v[68:71] offset:14336
    ds_write_b128 v2, v[72:75] offset:15360
    s_waitcnt lgkmcnt(0)
    s_barrier
    s_lshl_b32 s62, s3, 11
    v_add_u32 v2, s62, v5
    v_add_u32 v3, 0x10000, v2
    ds_read_b128 v[148:151], v2 offset:0
    ds_read_b128 v[152:155], v2 offset:1024
    ds_read_b128 v[156:159], v2 offset:16384
    ds_read_b128 v[160:163], v2 offset:17408
    ds_read_b128 v[164:167], v2 offset:32768
    ds_read_b128 v[168:171], v2 offset:33792
    ds_read_b128 v[172:175], v2 offset:49152
    ds_read_b128 v[176:179], v2 offset:50176
    ds_read_b128 v[180:183], v3 offset:0
    ds_read_b128 v[184:187], v3 offset:1024
    ds_read_b128 v[188:191], v3 offset:16384
    ds_read_b128 v[192:195], v3 offset:17408
    ds_read_b128 v[196:199], v3 offset:32768
    ds_read_b128 v[200:203], v3 offset:33792
    ds_read_b128 v[204:207], v3 offset:49152
    ds_read_b128 v[208:211], v3 offset:50176
    v_mul_u32_u24 v124, 896, v7
    v_lshl_add_u32 v124, v6, 3, v124
    s_mul_i32 s62, s54, 28672
    s_lshl_b32 s63, s52, 6
    s_add_u32 s62, s62, s63
    s_lshl_b32 s63, s53, 5
    s_add_u32 s62, s62, s63
    s_waitcnt vmcnt(0) lgkmcnt(0)
    v_add_f32 v148, v148, v180
    v_add_f32 v149, v149, v181
    v_add_f32 v150, v150, v182
    v_add_f32 v151, v151, v183
    v_add_f32 v152, v152, v184
    v_add_f32 v153, v153, v185
    v_add_f32 v154, v154, v186
    v_add_f32 v155, v155, v187
    v_add_f32 v156, v156, v188
    v_add_f32 v157, v157, v189
    v_add_f32 v158, v158, v190
    v_add_f32 v159, v159, v191
    v_add_f32 v160, v160, v192
    v_add_f32 v161, v161, v193
    v_add_f32 v162, v162, v194
    v_add_f32 v163, v163, v195
    v_add_f32 v164, v164, v196
    v_add_f32 v165, v165, v197
    v_add_f32 v166, v166, v198
    v_add_f32 v167, v167, v199
    v_add_f32 v168, v168, v200
    v_add_f32 v169, v169, v201
    v_add_f32 v170, v170, v202
    v_add_f32 v171, v171, v203
    v_add_f32 v172, v172, v204
    v_add_f32 v173, v173, v205
    v_add_f32 v174, v174, v206
    v_add_f32 v175, v175, v207
    v_add_f32 v176, v176, v208
    v_add_f32 v177, v177, v209
    v_add_f32 v178, v178, v210
    v_add_f32 v179, v179, v211
    v_add_f32 v148, v148, v164
    v_add_f32 v149, v149, v165
    v_add_f32 v150, v150, v166
    v_add_f32 v151, v151, v167
    v_add_f32 v152, v152, v168
    v_add_f32 v153, v153, v169
    v_add_f32 v154, v154, v170
    v_add_f32 v155, v155, v171
    v_add_f32 v156, v156, v172
    v_add_f32 v157, v157, v173
    v_add_f32 v158, v158, v174
    v_add_f32 v159, v159, v175
    v_add_f32 v160, v160, v176
    v_add_f32 v161, v161, v177
    v_add_f32 v162, v162, v178
    v_add_f32 v163, v163, v179
    v_add_f32 v148, v148, v156
    v_add_f32 v149, v149, v157
    v_add_f32 v150, v150, v158
    v_add_f32 v151, v151, v159
    v_add_f32 v152, v152, v160
    v_add_f32 v153, v153, v161
    v_add_f32 v154, v154, v162
    v_add_f32 v155, v155, v163
    v_add_f32 v136, v136, v220
    v_add_f32 v137, v137, v221
    v_add_f32 v138, v138, v222
    v_add_f32 v139, v139, v223
    v_add_f32 v140, v140, v224
    v_add_f32 v141, v141, v225
    v_add_f32 v142, v142, v226
    v_add_f32 v143, v143, v227
    v_cvt_pk_bf16_f32 v212, v136, v137
    v_lshlrev_b32 v136, 16, v212
    v_and_b32 v137, 0xffff0000, v212
    v_cvt_pk_bf16_f32 v212, v138, v139
    v_lshlrev_b32 v138, 16, v212
    v_and_b32 v139, 0xffff0000, v212
    v_cvt_pk_bf16_f32 v212, v140, v141
    v_lshlrev_b32 v140, 16, v212
    v_and_b32 v141, 0xffff0000, v212
    v_cvt_pk_bf16_f32 v212, v142, v143
    v_lshlrev_b32 v142, 16, v212
    v_and_b32 v143, 0xffff0000, v212
    v_lshlrev_b32 v212, 16, v128
    v_lshlrev_b32 v213, 16, v129
    v_fma_f32 v212, v148, v136, v212
    v_fma_f32 v213, v149, v137, v213
    v_cvt_pk_bf16_f32 v214, v212, v213
    v_lshlrev_b32 v212, 16, v130
    v_lshlrev_b32 v213, 16, v131
    v_fma_f32 v212, v150, v138, v212
    v_fma_f32 v213, v151, v139, v213
    v_cvt_pk_bf16_f32 v215, v212, v213
    buffer_store_dwordx2 v[214:215], v124, s[24:27], s62 offen offset:0
    v_lshlrev_b32 v212, 16, v132
    v_lshlrev_b32 v213, 16, v133
    v_fma_f32 v212, v152, v140, v212
    v_fma_f32 v213, v153, v141, v213
    v_cvt_pk_bf16_f32 v216, v212, v213
    v_lshlrev_b32 v212, 16, v134
    v_lshlrev_b32 v213, 16, v135
    v_fma_f32 v212, v154, v142, v212
    v_fma_f32 v213, v155, v143, v213
    v_cvt_pk_bf16_f32 v217, v212, v213
    buffer_store_dwordx2 v[216:217], v124, s[24:27], s62 offen offset:16
MG_END:
    s_endpgm
CODE_END:
.section .rodata,"a"
.p2align 6
.amdhsa_kernel adaLN_cond__ssm_conv_h3__geglu_ffn__prompt_kernel
  .amdhsa_next_free_vgpr 256
  .amdhsa_next_free_sgpr 102
  .amdhsa_accum_offset 256
  .amdhsa_group_segment_fixed_size 0
  .amdhsa_kernarg_size 120
  .amdhsa_user_sgpr_count 2
  .amdhsa_user_sgpr_kernarg_segment_ptr 1
  .amdhsa_system_sgpr_workgroup_id_x 1
.end_amdhsa_kernel
```
